```python
import torch

def _softmax(x, axis=-1):
    return torch.softmax(x, dim=axis)
def _gelu(x):
    return torch.nn.functional.gelu(x, approximate="tanh")
def _silu(x):
    return torch.nn.functional.silu(x)
def _sigmoid(x):
    return torch.sigmoid(x)
def _layernorm(x, axis=-1, eps=1e-5):
    m = x.mean(dim=axis, keepdim=True)
    v = x.var(dim=axis, keepdim=True, unbiased=False)
    return (x - m) / torch.sqrt(v + eps)
def _scatter_add(tgt, idx, src, axis=0):
    return tgt.clone().index_add_(axis, idx, src)
def _segment_sum(src, seg, n):
    out = torch.zeros((n,) + src.shape[1:], dtype=src.dtype)
    return out.index_add_(0, seg, src)
def _pad(x, pw):
    flat = tuple(v for pair in reversed(pw) for v in pair)
    return torch.nn.functional.pad(x, flat)

kernel_name = 'gated_mix__mha_block__moe_arch_mod__prompt'

def setup_inputs():

    _w = (lambda a: (lambda t: t.to(torch.bfloat16) if t.is_floating_point() else t)(torch.as_tensor(a)))
    def _A_setup():
        B, S, D, H = 1, 2048, 512, 32
        return {
            "x": _w((lambda *s: torch.randn(*s, dtype=torch.bfloat16) * 0.05)(B, S, D)),
            "wqkv": _w((lambda *s: torch.randn(*s, dtype=torch.bfloat16) * 0.8)(D, 3 * D)),
            "wo": _w((lambda *s: torch.randn(*s, dtype=torch.bfloat16) * 0.1)(D, D)),
        }
    _A_in = _A_setup()

    def _B_setup():
        B, S, D, F, C = 1, 2048, 512, 1792, 1
        return {
            "x": _w((lambda *s: torch.randn(*s, dtype=torch.bfloat16) * 0.05)(B, S, D)),
            "w_r": _w((lambda *s: torch.randn(*s, dtype=torch.bfloat16) * 1.6)(D)),
            "w_gate": _w((lambda *s: torch.randn(*s, dtype=torch.bfloat16) * 0.2)(D, F)),
            "w_up": _w((lambda *s: torch.randn(*s, dtype=torch.bfloat16) * 0.2)(D, F)),
            "w_down": _w((lambda *s: torch.randn(*s, dtype=torch.bfloat16) * 0.2)(F, D)),
        }
    _B_in = _B_setup()

    return {
        "A_x": _A_in["x"],
        "A_wqkv": _A_in["wqkv"],
        "A_wo": _A_in["wo"],
        "B_x": _B_in["x"],
        "B_w_r": _B_in["w_r"],
        "B_w_gate": _B_in["w_gate"],
        "B_w_up": _B_in["w_up"],
        "B_w_down": _B_in["w_down"],
        "gate_w": _w((lambda *s: torch.randn(*s, dtype=torch.bfloat16) * 0.05)(512) * 16.0),
    }

def reference(A_x, A_wqkv, A_wo, B_x, B_w_r, B_w_gate, B_w_up, B_w_down, gate_w):
    def _A_ref(x, wqkv, wo):
        B, S, D = x.shape
        H = 32
        Dh = D // H
        qkv = (lambda x, *d: x.permute(*d))((x @ wqkv).reshape(B, S, 3, H, Dh), 2, 0, 3, 1, 4)
        q, k, v = qkv[0], qkv[1], qkv[2]
        scores = torch.einsum("bhqd,bhkd->bhqk", q, k) * (Dh ** -0.5)
        p = _softmax(scores, axis=-1)
        o = torch.einsum("bhqk,bhkd->bhqd", p, v)
        return (lambda x, *d: x.permute(*d))(o, 0, 2, 1, 3).reshape(B, S, D) @ wo

    def _B_ref(x, w_r, w_gate, w_up, w_down):
        B, S, D = x.shape
        C = 1
        r = x @ w_r
        idx = torch.argsort(-r, axis=-1)[:, :C]
        idx_e = (lambda x, n, axis: torch.repeat_interleave(x, n, dim=axis))(idx.reshape(B, C, 1), D, axis=2)
        x_sel = (lambda x, i, axis: torch.take_along_dim(x, i, dim=axis))(x, idx_e, axis=1)
        g = _silu(x_sel @ w_gate)
        u = x_sel @ w_up
        y = (g * u) @ w_down
        r_sel = _sigmoid((lambda x, i, axis: torch.take_along_dim(x, i, dim=axis))(r, idx, axis=1))
        y = y * r_sel.reshape(B, C, 1)
        b_off = (torch.arange(B) * S).reshape(B, 1)
        flat_idx = (idx + b_off).reshape(B * C)
        zero = (x * 0.0).reshape(B * S, D)
        upd = _scatter_add(zero, flat_idx, y.reshape(B * C, D), axis=0)
        return x + upd.reshape(B, S, D)

    x = A_x
    g = _sigmoid((x * gate_w).sum(-1, keepdims=True))
    a = _A_ref(x, A_wqkv, A_wo)
    b = _B_ref(x, B_w_r, B_w_gate, B_w_up, B_w_down)
    return g * a + (1 - g) * b
```

```asm
; @launch grid=(256,1,1) block=(512,1,1) lds=163840
.amdgcn_target "amdgcn-amd-amdhsa--gfx950"
.text
.globl gated_mix__mha_block__moe_arch_mod__prompt_kernel
.p2align 12
.p2align 8
.type gated_mix__mha_block__moe_arch_mod__prompt_kernel,@function
gated_mix__mha_block__moe_arch_mod__prompt_kernel:
    s_cmp_ge_u32 s2, 256
    s_cbranch_scc1 L_EXIT
    s_load_dwordx4 s[4:7], s[0:1], 0
    s_load_dwordx2 s[24:25], s[0:1], 88
    s_load_dwordx2 s[8:9], s[0:1], 16
    s_load_dwordx8 s[12:19], s[0:1], 32
    s_load_dwordx4 s[20:23], s[0:1], 64
    v_lshrrev_b32 v1, 6, v0
    v_and_b32 v2, 63, v0
    s_and_b32 s28, s2, 7
    v_readfirstlane_b32 s27, v1
    s_lshr_b32 s29, s2, 3
    s_lshr_b32 s48, s28, 1
    s_lshl_b32 s48, s48, 3
    s_lshr_b32 s31, s29, 2
    s_add_u32 s48, s48, s31
    s_and_b32 s30, s29, 3
    s_and_b32 s49, s28, 1
    s_lshl_b32 s49, s49, 2
    s_add_u32 s49, s49, s30
    s_lshl_b32 s50, s30, 1
    s_add_u32 s50, s50, s31
    s_and_b32 s50, s50, 7
    v_lshlrev_b32 v3, 4, v2
    s_cmp_lt_u32 s27, 4
    s_cbranch_scc1 P1_COMPUTE
    s_sub_u32 s51, s27, 4
    s_lshl_b32 s57, s48, 16
    s_lshl_b32 s58, s51, 14
    s_add_u32 s57, s57, s58
    s_mul_i32 s58, s51, 49152
    s_lshl_b32 s59, s49, 7
    s_add_u32 s58, s58, s59
    v_lshrrev_b32 v4, 3, v2
    v_and_b32 v5, 7, v2
    v_lshrrev_b32 v6, 1, v4
    v_xor_b32 v6, v5, v6
    v_lshlrev_b32 v6, 4, v6
    v_lshl_add_u32 v6, v4, 10, v6
    v_add_u32 v8, s57, v6
    v_xor_b32 v9, 64, v8
    v_add_u32 v9, 7168, v9
    v_lshlrev_b32 v7, 1, v4
    v_and_b32 v7, 4, v7
    v_xor_b32 v5, v5, v7
    v_lshlrev_b32 v5, 4, v5
    v_mul_u32_u24 v4, 3072, v4
    v_add3_u32 v10, v4, v5, s58
    v_add_u32 v11, 23552, v10
    s_mov_b32 s38, 0x200000
    s_mov_b32 s39, 0x00020000
    s_mov_b32 s42, 0x180000
    s_mov_b32 s43, 0x00020000
    s_lshl_b32 s60, s51, 11
    s_add_u32 s61, s60, 0x10000
    s_mov_b32 s62, 0
    s_mov_b32 s65, 0x818000
    s_waitcnt lgkmcnt(0)
    s_mov_b32 s36, s4
    s_mov_b32 s37, s5
    s_mov_b32 s40, s6
    s_mov_b32 s41, s7
    s_load_dword s26, s[24:25], s65
P1_LD_LOOP:
    s_add_u32 s63, s62, s50
    s_and_b32 s63, s63, 7
    s_lshl_b32 s64, s63, 7
    s_mul_i32 s63, s63, 0x30000
    s_mov_b32 m0, s60
    s_nop 0
    s_cmp_lt_u32 s62, 4
    s_cbranch_scc1 P1_LD_ISSUE
    s_waitcnt vmcnt(18) lgkmcnt(0)
    s_barrier
P1_LD_ISSUE:
    buffer_load_dwordx4 v8, s[36:39], s64 offen lds
    buffer_load_dwordx4 v9, s[36:39], s64 offen offset:1024 lds
    s_mov_b32 m0, s61
    s_add_u32 s64, s63, 1024
    buffer_load_dwordx4 v10, s[40:43], s64 offen lds
    buffer_load_dwordx4 v11, s[40:43], s64 offen offset:1024 lds
    s_add_u32 m0, s61, 0x2000
    s_add_u32 s64, s63, 2048
    buffer_load_dwordx4 v10, s[40:43], s64 offen lds
    buffer_load_dwordx4 v11, s[40:43], s64 offen offset:1024 lds
    s_add_u32 s60, s60, 0x2000
    s_add_u32 s61, s61, 0x4000
    s_sub_u32 s64, s61, 0x14000
    s_cmp_ge_u32 s61, 0x24000
    s_cmov_b32 s61, s64
    s_add_u32 s62, s62, 1
    s_cmp_lt_u32 s62, 8
    s_cbranch_scc1 P1_LD_LOOP
    s_lshl_b32 s60, s51, 11
    s_add_u32 s63, s50, 0
    s_and_b32 s63, s63, 7
    s_mul_i32 s63, s63, 0x30000
    s_add_u32 m0, s60, 0x1c000
    s_add_u32 s64, s50, 1
    s_and_b32 s64, s64, 7
    s_mul_i32 s64, s64, 0x30000
    s_waitcnt vmcnt(18)
    s_barrier
    buffer_load_dwordx4 v10, s[40:43], s63 offen lds
    buffer_load_dwordx4 v11, s[40:43], s63 offen offset:1024 lds
    s_add_u32 m0, m0, 0x2000
    s_nop 0
    buffer_load_dwordx4 v10, s[40:43], s64 offen lds
    buffer_load_dwordx4 v11, s[40:43], s64 offen offset:1024 lds
    s_add_u32 s63, s50, 2
    s_and_b32 s63, s63, 7
    s_mul_i32 s63, s63, 0x30000
    s_add_u32 m0, s60, 0x20000
    s_add_u32 s64, s50, 3
    s_and_b32 s64, s64, 7
    s_mul_i32 s64, s64, 0x30000
    s_waitcnt vmcnt(16)
    s_barrier
    buffer_load_dwordx4 v10, s[40:43], s63 offen lds
    buffer_load_dwordx4 v11, s[40:43], s63 offen offset:1024 lds
    s_add_u32 m0, m0, 0x2000
    s_nop 0
    buffer_load_dwordx4 v10, s[40:43], s64 offen lds
    buffer_load_dwordx4 v11, s[40:43], s64 offen offset:1024 lds
    s_add_u32 s63, s50, 4
    s_and_b32 s63, s63, 7
    s_mul_i32 s63, s63, 0x30000
    s_add_u32 m0, s60, 0x10000
    s_add_u32 s64, s50, 5
    s_and_b32 s64, s64, 7
    s_mul_i32 s64, s64, 0x30000
    s_waitcnt vmcnt(14)
    s_barrier
    buffer_load_dwordx4 v10, s[40:43], s63 offen lds
    buffer_load_dwordx4 v11, s[40:43], s63 offen offset:1024 lds
    s_add_u32 m0, m0, 0x2000
    s_nop 0
    buffer_load_dwordx4 v10, s[40:43], s64 offen lds
    buffer_load_dwordx4 v11, s[40:43], s64 offen offset:1024 lds
    s_add_u32 s63, s50, 6
    s_and_b32 s63, s63, 7
    s_mul_i32 s63, s63, 0x30000
    s_add_u32 m0, s60, 0x14000
    s_add_u32 s64, s50, 7
    s_and_b32 s64, s64, 7
    s_mul_i32 s64, s64, 0x30000
    s_waitcnt vmcnt(12)
    s_barrier
    buffer_load_dwordx4 v10, s[40:43], s63 offen lds
    buffer_load_dwordx4 v11, s[40:43], s63 offen offset:1024 lds
    s_add_u32 m0, m0, 0x2000
    s_nop 0
    buffer_load_dwordx4 v10, s[40:43], s64 offen lds
    buffer_load_dwordx4 v11, s[40:43], s64 offen offset:1024 lds
    s_mov_b32 s32, s24
    s_mov_b32 s33, s25
    s_mov_b32 s34, 0x10000000
    s_mov_b32 s35, 0x00020000
    s_mul_i32 s26, s26, 0x9e3779b1
    s_add_u32 s26, s26, 0x7f4a7c15
    s_lshr_b32 s52, s51, 1
    s_and_b32 s51, s51, 1
    v_lshrrev_b32 v4, 5, v2
    v_and_b32 v5, 31, v2
    v_bfe_u32 v6, v2, 1, 3
    v_xor_b32 v6, v6, v4
    v_lshlrev_b32 v6, 4, v6
    s_lshl_b32 s53, s51, 12
    v_lshl_add_u32 v6, v5, 7, v6
    v_add_u32 v10, s53, v6
    v_xor_b32 v11, 32, v10
    v_xor_b32 v12, 64, v10
    v_xor_b32 v13, 0x60, v10
    v_bfe_u32 v6, v2, 2, 2
    v_lshl_add_u32 v7, v4, 3, v6
    v_lshlrev_b32 v7, 7, v7
    v_lshrrev_b32 v6, 1, v6
    v_xor_b32 v6, s52, v6
    v_lshl_add_u32 v7, v6, 6, v7
    v_bfe_u32 v6, v2, 4, 1
    v_lshl_add_u32 v7, v6, 5, v7
    v_and_b32 v6, 3, v2
    v_lshl_add_u32 v14, v6, 3, v7
    v_add_u32 v14, 0x10000, v14
    v_add_u32 v15, 0xc000, v14
    s_lshl_b32 s56, s52, 12
    s_lshl_b32 s57, s51, 10
    s_add_u32 s56, s56, s57
    s_add_u32 s56, s56, 0x25000
    v_add_u32 v1, s56, v3
    s_mov_b32 s64, 0x3eb8aa3b
    s_mov_b32 s65, 0x3eb8aa3b
    s_mov_b32 s58, 0xc000
    s_mov_b32 s62, 0
    v_mov_b64 v[32:33], 0
    v_mov_b64 v[34:35], 0
    v_mov_b64 v[36:37], 0
    v_mov_b64 v[38:39], 0
    v_mov_b64 v[40:41], 0
    v_mov_b64 v[42:43], 0
    v_mov_b64 v[44:45], 0
    v_mov_b64 v[46:47], 0
    s_waitcnt vmcnt(0)
    s_barrier
    ds_read_b128 v[64:67], v10 offset:0
    ds_read_b64_tr_b16 v[68:69], v15 offset:0
    ds_read_b64_tr_b16 v[70:71], v15 offset:512
    ds_read_b128 v[72:75], v11 offset:0
    ds_read_b64_tr_b16 v[76:77], v15 offset:2048
    ds_read_b64_tr_b16 v[78:79], v15 offset:2560
    ds_read_b128 v[80:83], v12 offset:0
    ds_read_b64_tr_b16 v[84:85], v15 offset:4096
    ds_read_b64_tr_b16 v[86:87], v15 offset:4608
    ds_read_b128 v[88:91], v13 offset:0
    ds_read_b64_tr_b16 v[92:93], v15 offset:6144
    ds_read_b64_tr_b16 v[94:95], v15 offset:6656
P1_Q:
    s_waitcnt lgkmcnt(9)
    v_mfma_f32_32x32x16_bf16 v[32:47], v[68:71], v[64:67], v[32:47]
    ds_read_b128 v[96:99], v10 offset:8192
    ds_read_b64_tr_b16 v[100:101], v15 offset:8192
    ds_read_b64_tr_b16 v[102:103], v15 offset:8704
    v_add_u32 v10, 0x4000, v10
    s_waitcnt lgkmcnt(9)
    v_mfma_f32_32x32x16_bf16 v[32:47], v[76:79], v[72:75], v[32:47]
    ds_read_b128 v[104:107], v11 offset:8192
    ds_read_b64_tr_b16 v[108:109], v15 offset:10240
    ds_read_b64_tr_b16 v[110:111], v15 offset:10752
    v_add_u32 v11, 0x4000, v11
    s_add_u32 s58, s58, 0x4000
    s_cmp_eq_u32 s58, 0x14000
    s_cmov_b32 s58, 0
    s_add_u32 s62, s62, 1
    s_waitcnt lgkmcnt(9)
    v_mfma_f32_32x32x16_bf16 v[32:47], v[84:87], v[80:83], v[32:47]
    ds_read_b128 v[112:115], v12 offset:8192
    ds_read_b64_tr_b16 v[116:117], v15 offset:12288
    ds_read_b64_tr_b16 v[118:119], v15 offset:12800
    v_add_u32 v12, 0x4000, v12
    s_waitcnt lgkmcnt(9)
    v_mfma_f32_32x32x16_bf16 v[32:47], v[92:95], v[88:91], v[32:47]
    ds_read_b128 v[120:123], v13 offset:8192
    ds_read_b64_tr_b16 v[124:125], v15 offset:14336
    ds_read_b64_tr_b16 v[126:127], v15 offset:14848
    v_add_u32 v13, 0x4000, v13
    v_add_u32 v15, s58, v14
    s_waitcnt lgkmcnt(9)
    v_mfma_f32_32x32x16_bf16 v[32:47], v[100:103], v[96:99], v[32:47]
    ds_read_b128 v[64:67], v10 offset:0
    ds_read_b64_tr_b16 v[68:69], v15 offset:0
    ds_read_b64_tr_b16 v[70:71], v15 offset:512
    s_waitcnt lgkmcnt(9)
    v_mfma_f32_32x32x16_bf16 v[32:47], v[108:111], v[104:107], v[32:47]
    ds_read_b128 v[72:75], v11 offset:0
    ds_read_b64_tr_b16 v[76:77], v15 offset:2048
    ds_read_b64_tr_b16 v[78:79], v15 offset:2560
    s_waitcnt lgkmcnt(9)
    v_mfma_f32_32x32x16_bf16 v[32:47], v[116:119], v[112:115], v[32:47]
    ds_read_b128 v[80:83], v12 offset:0
    ds_read_b64_tr_b16 v[84:85], v15 offset:4096
    ds_read_b64_tr_b16 v[86:87], v15 offset:4608
    s_waitcnt lgkmcnt(9)
    v_mfma_f32_32x32x16_bf16 v[32:47], v[124:127], v[120:123], v[32:47]
    ds_read_b128 v[88:91], v13 offset:0
    ds_read_b64_tr_b16 v[92:93], v15 offset:6144
    ds_read_b64_tr_b16 v[94:95], v15 offset:6656
    s_cmp_lt_u32 s62, 4
    s_cbranch_scc1 P1_Q
    s_nop 6
    v_pk_mul_f32 v[32:33], v[32:33], s[64:65]
    v_pk_mul_f32 v[34:35], v[34:35], s[64:65]
    v_pk_mul_f32 v[36:37], v[36:37], s[64:65]
    v_pk_mul_f32 v[38:39], v[38:39], s[64:65]
    v_pk_mul_f32 v[40:41], v[40:41], s[64:65]
    v_pk_mul_f32 v[42:43], v[42:43], s[64:65]
    v_pk_mul_f32 v[44:45], v[44:45], s[64:65]
    v_pk_mul_f32 v[46:47], v[46:47], s[64:65]
    v_cvt_pk_bf16_f32 v128, v32, v33
    v_cvt_pk_bf16_f32 v129, v34, v35
    v_cvt_pk_bf16_f32 v130, v36, v37
    v_cvt_pk_bf16_f32 v131, v38, v39
    v_cvt_pk_bf16_f32 v132, v40, v41
    v_cvt_pk_bf16_f32 v133, v42, v43
    v_cvt_pk_bf16_f32 v134, v44, v45
    v_cvt_pk_bf16_f32 v135, v46, v47
    ds_write_b128 v1, v[128:131]
    ds_write_b128 v1, v[132:135] offset:2048
    s_branch P2_SETUP
P1_COMPUTE:
    s_and_b32 s51, s27, 1
    s_lshr_b32 s52, s27, 1
    s_mov_b32 s65, 0x818000
    v_mov_b32 v21, 0
    v_lshrrev_b32 v4, 5, v2
    v_and_b32 v5, 31, v2
    v_bfe_u32 v6, v2, 1, 3
    v_xor_b32 v6, v6, v4
    v_lshlrev_b32 v6, 4, v6
    s_lshl_b32 s53, s51, 12
    v_lshl_add_u32 v6, v5, 7, v6
    v_add_u32 v10, s53, v6
    v_xor_b32 v11, 32, v10
    v_xor_b32 v12, 64, v10
    v_xor_b32 v13, 0x60, v10
    v_bfe_u32 v6, v2, 2, 2
    v_lshl_add_u32 v7, v4, 3, v6
    v_lshlrev_b32 v7, 7, v7
    v_lshrrev_b32 v6, 1, v6
    v_xor_b32 v6, s52, v6
    v_lshl_add_u32 v7, v6, 6, v7
    v_bfe_u32 v6, v2, 4, 1
    v_lshl_add_u32 v7, v6, 5, v7
    v_and_b32 v6, 3, v2
    v_lshl_add_u32 v14, v6, 3, v7
    v_add_u32 v14, 0x10000, v14
    v_mov_b32 v15, v14
    v_mov_b64 v[16:17], v[10:11]
    v_mov_b64 v[18:19], v[12:13]
    s_waitcnt lgkmcnt(0)
    s_mov_b32 s32, s24
    s_mov_b32 s33, s25
    s_mov_b32 s34, 0x10000000
    s_mov_b32 s35, 0x00020000
    buffer_load_dword v21, v21, s[32:35], s65 offen
    s_cmp_lg_u32 s27, 1
    s_cbranch_scc1 P1_NOW
    s_mov_b32 s40, s12
    s_mov_b32 s41, s13
    s_mov_b32 s42, 0x400
    s_mov_b32 s43, 0x00020000
    s_mov_b32 s44, s20
    s_mov_b32 s45, s21
    s_mov_b32 s46, 0x400
    s_mov_b32 s47, 0x00020000
    s_lshl_b32 s53, s50, 7
    v_add_u32 v6, s53, v3
    v_and_b32 v6, 0x3ff, v6
    buffer_load_dwordx4 v[224:227], v6, s[40:43], 0 offen
    buffer_load_dwordx4 v[228:231], v6, s[44:47], 0 offen
    s_lshl_b32 s55, s2, 8
    s_add_u32 s55, s55, 0x860000
    v_lshlrev_b32 v7, 2, v2
    v_mov_b32 v24, 0
    buffer_store_dword v24, v7, s[32:35], s55 offen sc1
P1_NOW:
    v_lshlrev_b32 v6, 2, v2
    v_add_u32 v6, 0x27000, v6
    v_mov_b32 v7, 0
    ds_write_b32 v6, v7
    s_lshl_b32 s53, s48, 1
    s_add_u32 s53, s53, s51
    s_lshl_b32 s54, s49, 2
    s_lshl_b32 s55, s52, 1
    s_add_u32 s54, s54, s55
    s_lshl_b32 s59, s53, 11
    s_lshl_b32 s57, s54, 17
    s_add_u32 s59, s59, s57
    s_add_u32 s59, s59, 0x200000
    s_add_u32 s60, s59, 0x20000
    s_lshl_b32 s54, s49, 5
    s_add_u32 s54, s54, s48
    s_lshl_b32 s54, s54, 5
    s_add_u32 s54, s54, 0x820000
    v_and_b32 v6, 0x33, v2
    v_and_b32 v7, 4, v2
    v_lshl_or_b32 v6, v7, 1, v6
    v_and_b32 v7, 8, v2
    v_lshrrev_b32 v7, 1, v7
    v_or_b32 v6, v6, v7
    v_lshlrev_b32 v22, 4, v6
    v_and_b32 v6, 0x2f, v2
    v_lshlrev_b32 v6, 4, v6
    v_bfe_u32 v7, v2, 4, 1
    v_lshl_add_u32 v23, v7, 17, v6
    v_mov_b64 v[32:33], 0
    v_mov_b64 v[34:35], 0
    v_mov_b64 v[36:37], 0
    v_mov_b64 v[38:39], 0
    v_mov_b64 v[40:41], 0
    v_mov_b64 v[42:43], 0
    v_mov_b64 v[44:45], 0
    v_mov_b64 v[46:47], 0
    v_mov_b64 v[48:49], 0
    v_mov_b64 v[50:51], 0
    v_mov_b64 v[52:53], 0
    v_mov_b64 v[54:55], 0
    v_mov_b64 v[56:57], 0
    v_mov_b64 v[58:59], 0
    v_mov_b64 v[60:61], 0
    v_mov_b64 v[62:63], 0
    s_mov_b32 s62, 0
    s_mov_b32 s57, 0
    s_mov_b32 s58, 0
    v_lshlrev_b32 v7, 2, v2
    s_waitcnt lgkmcnt(0)
    s_barrier
    ds_read_b128 v[64:67], v16
    ds_read_b64_tr_b16 v[68:69], v15 offset:0
    ds_read_b64_tr_b16 v[70:71], v15 offset:512
    ds_read_b64_tr_b16 v[72:73], v15 offset:8192
    ds_read_b64_tr_b16 v[74:75], v15 offset:8704
    ds_read_b128 v[76:79], v17
    ds_read_b64_tr_b16 v[80:81], v15 offset:2048
    ds_read_b64_tr_b16 v[82:83], v15 offset:2560
    ds_read_b64_tr_b16 v[84:85], v15 offset:10240
    ds_read_b64_tr_b16 v[86:87], v15 offset:10752
    ds_read_b128 v[88:91], v18
    ds_read_b64_tr_b16 v[92:93], v15 offset:4096
    ds_read_b64_tr_b16 v[94:95], v15 offset:4608
    ds_read_b64_tr_b16 v[96:97], v15 offset:12288
    ds_read_b64_tr_b16 v[98:99], v15 offset:12800
    ds_read_b128 v[100:103], v19
    ds_read_b64_tr_b16 v[104:105], v15 offset:6144
    ds_read_b64_tr_b16 v[106:107], v15 offset:6656
    ds_read_b64_tr_b16 v[108:109], v15 offset:14336
    ds_read_b64_tr_b16 v[110:111], v15 offset:14848
    s_add_u32 s62, s62, 1
    s_add_u32 s57, s57, 0x2000
    s_and_b32 s57, s57, 0xffff
    s_add_u32 s58, s58, 0x4000
    s_cmp_eq_u32 s58, 0x14000
    s_cmov_b32 s58, 0
    v_add_u32 v16, s57, v10
    v_add_u32 v15, s58, v14
    v_add_u32 v17, s57, v11
    v_add_u32 v18, s57, v12
    v_add_u32 v19, s57, v13
P1_KV:
    s_waitcnt lgkmcnt(0)
    s_barrier
    v_mfma_f32_32x32x16_bf16 v[32:47], v[68:71], v[64:67], v[32:47]
    ds_read_b128 v[128:131], v16
    ds_read_b64_tr_b16 v[132:133], v15 offset:0
    ds_read_b64_tr_b16 v[134:135], v15 offset:512
    v_mfma_f32_32x32x16_bf16 v[48:63], v[64:67], v[72:75], v[48:63]
    ds_read_b64_tr_b16 v[136:137], v15 offset:8192
    ds_read_b64_tr_b16 v[138:139], v15 offset:8704
    ds_read_b128 v[140:143], v17
    v_mfma_f32_32x32x16_bf16 v[32:47], v[80:83], v[76:79], v[32:47]
    ds_read_b64_tr_b16 v[144:145], v15 offset:2048
    ds_read_b64_tr_b16 v[146:147], v15 offset:2560
    ds_read_b64_tr_b16 v[148:149], v15 offset:10240
    v_mfma_f32_32x32x16_bf16 v[48:63], v[76:79], v[84:87], v[48:63]
    ds_read_b64_tr_b16 v[150:151], v15 offset:10752
    ds_read_b128 v[152:155], v18
    ds_read_b64_tr_b16 v[156:157], v15 offset:4096
    v_mfma_f32_32x32x16_bf16 v[32:47], v[92:95], v[88:91], v[32:47]
    ds_read_b64_tr_b16 v[158:159], v15 offset:4608
    ds_read_b64_tr_b16 v[160:161], v15 offset:12288
    ds_read_b64_tr_b16 v[162:163], v15 offset:12800
    v_mfma_f32_32x32x16_bf16 v[48:63], v[88:91], v[96:99], v[48:63]
    ds_read_b128 v[164:167], v19
    ds_read_b64_tr_b16 v[168:169], v15 offset:6144
    ds_read_b64_tr_b16 v[170:171], v15 offset:6656
    v_mfma_f32_32x32x16_bf16 v[32:47], v[104:107], v[100:103], v[32:47]
    ds_read_b64_tr_b16 v[172:173], v15 offset:14336
    ds_read_b64_tr_b16 v[174:175], v15 offset:14848
    v_mfma_f32_32x32x16_bf16 v[48:63], v[100:103], v[108:111], v[48:63]
    s_add_u32 s62, s62, 1
    s_add_u32 s57, s57, 0x2000
    s_and_b32 s57, s57, 0xffff
    s_add_u32 s58, s58, 0x4000
    s_cmp_eq_u32 s58, 0x14000
    s_cmov_b32 s58, 0
    v_add_u32 v16, s57, v10
    v_add_u32 v15, s58, v14
    v_add_u32 v17, s57, v11
    v_add_u32 v18, s57, v12
    v_add_u32 v19, s57, v13
    s_cmp_eq_u32 s62, 8
    s_cbranch_scc1 P1_KVT
    s_waitcnt lgkmcnt(0)
    s_barrier
    v_mfma_f32_32x32x16_bf16 v[32:47], v[132:135], v[128:131], v[32:47]
    ds_read_b128 v[64:67], v16
    ds_read_b64_tr_b16 v[68:69], v15 offset:0
    ds_read_b64_tr_b16 v[70:71], v15 offset:512
    v_mfma_f32_32x32x16_bf16 v[48:63], v[128:131], v[136:139], v[48:63]
    ds_read_b64_tr_b16 v[72:73], v15 offset:8192
    ds_read_b64_tr_b16 v[74:75], v15 offset:8704
    ds_read_b128 v[76:79], v17
    v_mfma_f32_32x32x16_bf16 v[32:47], v[144:147], v[140:143], v[32:47]
    ds_read_b64_tr_b16 v[80:81], v15 offset:2048
    ds_read_b64_tr_b16 v[82:83], v15 offset:2560
    ds_read_b64_tr_b16 v[84:85], v15 offset:10240
    v_mfma_f32_32x32x16_bf16 v[48:63], v[140:143], v[148:151], v[48:63]
    ds_read_b64_tr_b16 v[86:87], v15 offset:10752
    ds_read_b128 v[88:91], v18
    ds_read_b64_tr_b16 v[92:93], v15 offset:4096
    v_mfma_f32_32x32x16_bf16 v[32:47], v[156:159], v[152:155], v[32:47]
    ds_read_b64_tr_b16 v[94:95], v15 offset:4608
    ds_read_b64_tr_b16 v[96:97], v15 offset:12288
    ds_read_b64_tr_b16 v[98:99], v15 offset:12800
    v_mfma_f32_32x32x16_bf16 v[48:63], v[152:155], v[160:163], v[48:63]
    ds_read_b128 v[100:103], v19
    ds_read_b64_tr_b16 v[104:105], v15 offset:6144
    ds_read_b64_tr_b16 v[106:107], v15 offset:6656
    v_mfma_f32_32x32x16_bf16 v[32:47], v[168:171], v[164:167], v[32:47]
    ds_read_b64_tr_b16 v[108:109], v15 offset:14336
    ds_read_b64_tr_b16 v[110:111], v15 offset:14848
    v_mfma_f32_32x32x16_bf16 v[48:63], v[164:167], v[172:175], v[48:63]
    s_add_u32 s62, s62, 1
    s_add_u32 s57, s57, 0x2000
    s_and_b32 s57, s57, 0xffff
    s_add_u32 s58, s58, 0x4000
    s_cmp_eq_u32 s58, 0x14000
    s_cmov_b32 s58, 0
    v_add_u32 v16, s57, v10
    v_add_u32 v15, s58, v14
    v_add_u32 v17, s57, v11
    v_add_u32 v18, s57, v12
    v_add_u32 v19, s57, v13
    s_branch P1_KV
P1_KVT:
    s_waitcnt lgkmcnt(0)
    v_mfma_f32_32x32x16_bf16 v[32:47], v[132:135], v[128:131], v[32:47]
    v_mfma_f32_32x32x16_bf16 v[48:63], v[128:131], v[136:139], v[48:63]
    v_mfma_f32_32x32x16_bf16 v[32:47], v[144:147], v[140:143], v[32:47]
    v_mfma_f32_32x32x16_bf16 v[48:63], v[140:143], v[148:151], v[48:63]
    v_mfma_f32_32x32x16_bf16 v[32:47], v[156:159], v[152:155], v[32:47]
    v_mfma_f32_32x32x16_bf16 v[48:63], v[152:155], v[160:163], v[48:63]
    v_mfma_f32_32x32x16_bf16 v[32:47], v[168:171], v[164:167], v[32:47]
    v_mfma_f32_32x32x16_bf16 v[48:63], v[164:167], v[172:175], v[48:63]
    s_waitcnt vmcnt(0)
    v_readfirstlane_b32 s26, v21
    s_nop 6
    s_mul_i32 s26, s26, 0x9e3779b1
    s_add_u32 s26, s26, 0x7f4a7c15
    v_mov_b32 v27, s26
    v_cvt_pk_bf16_f32 v192, v32, v33
    v_cvt_pk_bf16_f32 v193, v34, v35
    v_cvt_pk_bf16_f32 v194, v36, v37
    v_cvt_pk_bf16_f32 v195, v38, v39
    v_cvt_pk_bf16_f32 v196, v40, v41
    v_cvt_pk_bf16_f32 v197, v42, v43
    v_cvt_pk_bf16_f32 v198, v44, v45
    v_cvt_pk_bf16_f32 v199, v46, v47
    buffer_store_dwordx4 v[192:195], v22, s[32:35], s59 offen sc1
    buffer_store_dwordx4 v[196:199], v22, s[32:35], s60 offen sc1
    v_cvt_pk_bf16_f32 v200, v48, v49
    v_cvt_pk_bf16_f32 v201, v50, v51
    v_cvt_pk_bf16_f32 v202, v52, v53
    v_cvt_pk_bf16_f32 v203, v54, v55
    v_cvt_pk_bf16_f32 v204, v56, v57
    v_cvt_pk_bf16_f32 v205, v58, v59
    v_cvt_pk_bf16_f32 v206, v60, v61
    v_cvt_pk_bf16_f32 v207, v62, v63
    buffer_store_dwordx4 v[200:203], v23, s[32:35], s59 offen offset:1024 sc1
    buffer_store_dwordx4 v[204:207], v23, s[32:35], s59 offen offset:1280 sc1
    s_barrier
    v_mov_b32 v4, 0x27020
    v_mov_b32 v5, 1
    s_waitcnt vmcnt(0)
    s_mov_b64 exec, 1
    ds_add_rtn_u32 v6, v4, v5
    s_waitcnt lgkmcnt(0)
    v_cmp_eq_u32 vcc, 3, v6
    s_cbranch_vccz P1_NOKG
    buffer_store_dword v27, v7, s[32:35], s54 offen sc1
P1_NOKG:
    s_mov_b64 exec, -1
    s_cmp_lg_u32 s27, 1
    s_cbranch_scc1 P2_SETUP
    v_lshrrev_b32 v4, 3, v2
    v_lshlrev_b32 v4, 13, v4
    v_and_b32 v5, 7, v2
    s_and_b32 s53, s49, 1
    s_lshl_b32 s53, s53, 2
    v_xor_b32 v5, s53, v5
    v_lshl_add_u32 v4, v5, 4, v4
    s_lshl_b32 s53, s49, 10
    v_add_u32 v4, s53, v4
    v_xor_b32 v5, 16, v4
    v_xor_b32 v8, 32, v4
    v_xor_b32 v9, 48, v4
    ds_read_b128 v[128:131], v4 offset:0
    ds_read_b128 v[132:135], v4 offset:128
    ds_read_b128 v[136:139], v5 offset:256
    ds_read_b128 v[140:143], v5 offset:384
    ds_read_b128 v[144:147], v8 offset:512
    ds_read_b128 v[148:151], v8 offset:640
    ds_read_b128 v[152:155], v9 offset:768
    ds_read_b128 v[156:159], v9 offset:896
    v_mov_b64 v[168:169], 0
    v_mov_b64 v[170:171], 0
    v_mov_b64 v[172:173], 0
    v_mov_b64 v[174:175], 0
    v_mov_b64 v[176:177], 0
    v_mov_b64 v[178:179], 0
    v_mov_b64 v[180:181], 0
    v_mov_b64 v[182:183], 0
    s_lshl_b32 s66, s48, 3
    s_add_u32 s66, s66, s49
    v_and_b32 v6, 1, v2
    v_cmp_eq_u32 vcc, 0, v6
    v_and_b32 v6, 2, v2
    v_cmp_eq_u32 s[56:57], 0, v6
    v_and_b32 v24, 3, v2
    v_bfe_u32 v6, v2, 4, 1
    v_lshl_add_u32 v24, v6, 2, v24
    s_lshl_b32 s53, s66, 3
    v_add_u32 v24, s53, v24
    s_waitcnt lgkmcnt(0)
    v_dot2c_f32_bf16 v168, v128, v224
    v_dot2c_f32_bf16 v176, v128, v228
    v_dot2c_f32_bf16 v169, v132, v224
    v_dot2c_f32_bf16 v177, v132, v228
    v_dot2c_f32_bf16 v170, v136, v224
    v_dot2c_f32_bf16 v178, v136, v228
    v_dot2c_f32_bf16 v171, v140, v224
    v_dot2c_f32_bf16 v179, v140, v228
    v_dot2c_f32_bf16 v172, v144, v224
    v_dot2c_f32_bf16 v180, v144, v228
    v_dot2c_f32_bf16 v173, v148, v224
    v_dot2c_f32_bf16 v181, v148, v228
    v_dot2c_f32_bf16 v174, v152, v224
    v_dot2c_f32_bf16 v182, v152, v228
    v_dot2c_f32_bf16 v175, v156, v224
    v_dot2c_f32_bf16 v183, v156, v228
    v_dot2c_f32_bf16 v168, v129, v225
    v_dot2c_f32_bf16 v176, v129, v229
    v_dot2c_f32_bf16 v169, v133, v225
    v_dot2c_f32_bf16 v177, v133, v229
    v_dot2c_f32_bf16 v170, v137, v225
    v_dot2c_f32_bf16 v178, v137, v229
    v_dot2c_f32_bf16 v171, v141, v225
    v_dot2c_f32_bf16 v179, v141, v229
    v_dot2c_f32_bf16 v172, v145, v225
    v_dot2c_f32_bf16 v180, v145, v229
    v_dot2c_f32_bf16 v173, v149, v225
    v_dot2c_f32_bf16 v181, v149, v229
    v_dot2c_f32_bf16 v174, v153, v225
    v_dot2c_f32_bf16 v182, v153, v229
    v_dot2c_f32_bf16 v175, v157, v225
    v_dot2c_f32_bf16 v183, v157, v229
    v_dot2c_f32_bf16 v168, v130, v226
    v_dot2c_f32_bf16 v176, v130, v230
    v_dot2c_f32_bf16 v169, v134, v226
    v_dot2c_f32_bf16 v177, v134, v230
    v_dot2c_f32_bf16 v170, v138, v226
    v_dot2c_f32_bf16 v178, v138, v230
    v_dot2c_f32_bf16 v171, v142, v226
    v_dot2c_f32_bf16 v179, v142, v230
    v_dot2c_f32_bf16 v172, v146, v226
    v_dot2c_f32_bf16 v180, v146, v230
    v_dot2c_f32_bf16 v173, v150, v226
    v_dot2c_f32_bf16 v181, v150, v230
    v_dot2c_f32_bf16 v174, v154, v226
    v_dot2c_f32_bf16 v182, v154, v230
    v_dot2c_f32_bf16 v175, v158, v226
    v_dot2c_f32_bf16 v183, v158, v230
    v_dot2c_f32_bf16 v168, v131, v227
    v_dot2c_f32_bf16 v176, v131, v231
    v_dot2c_f32_bf16 v169, v135, v227
    v_dot2c_f32_bf16 v177, v135, v231
    v_dot2c_f32_bf16 v170, v139, v227
    v_dot2c_f32_bf16 v178, v139, v231
    v_dot2c_f32_bf16 v171, v143, v227
    v_dot2c_f32_bf16 v179, v143, v231
    v_dot2c_f32_bf16 v172, v147, v227
    v_dot2c_f32_bf16 v180, v147, v231
    v_dot2c_f32_bf16 v173, v151, v227
    v_dot2c_f32_bf16 v181, v151, v231
    v_dot2c_f32_bf16 v174, v155, v227
    v_dot2c_f32_bf16 v182, v155, v231
    v_dot2c_f32_bf16 v175, v159, v227
    v_dot2c_f32_bf16 v183, v159, v231
    s_nop 2
    v_permlane32_swap_b32 v168, v176
    v_permlane32_swap_b32 v169, v177
    v_permlane32_swap_b32 v170, v178
    v_permlane32_swap_b32 v171, v179
    v_permlane32_swap_b32 v172, v180
    v_permlane32_swap_b32 v173, v181
    v_permlane32_swap_b32 v174, v182
    v_permlane32_swap_b32 v175, v183
    s_nop 1
    v_add_f32 v168, v168, v176
    v_add_f32 v169, v169, v177
    v_add_f32 v170, v170, v178
    v_add_f32 v171, v171, v179
    v_add_f32 v172, v172, v180
    v_add_f32 v173, v173, v181
    v_add_f32 v174, v174, v182
    v_add_f32 v175, v175, v183
    s_nop 1
    v_permlane16_swap_b32 v168, v172
    v_permlane16_swap_b32 v169, v173
    v_permlane16_swap_b32 v170, v174
    v_permlane16_swap_b32 v171, v175
    s_nop 1
    v_add_f32 v168, v168, v172
    v_add_f32 v169, v169, v173
    v_add_f32 v170, v170, v174
    v_add_f32 v171, v171, v175
    v_add_f32_dpp v168, v168, v168 row_ror:8 row_mask:0xf bank_mask:0xf
    v_add_f32_dpp v169, v169, v169 row_ror:8 row_mask:0xf bank_mask:0xf
    v_add_f32_dpp v170, v170, v170 row_ror:8 row_mask:0xf bank_mask:0xf
    v_add_f32_dpp v171, v171, v171 row_ror:8 row_mask:0xf bank_mask:0xf
    v_add_f32_dpp v168, v168, v168 row_ror:4 row_mask:0xf bank_mask:0xf
    v_add_f32_dpp v169, v169, v169 row_ror:4 row_mask:0xf bank_mask:0xf
    v_add_f32_dpp v170, v170, v170 row_ror:4 row_mask:0xf bank_mask:0xf
    v_add_f32_dpp v171, v171, v171 row_ror:4 row_mask:0xf bank_mask:0xf
    v_add_f32_dpp v168, v168, v168 row_ror:2 row_mask:0xf bank_mask:0xf
    v_add_f32_dpp v169, v169, v169 row_ror:2 row_mask:0xf bank_mask:0xf
    v_add_f32_dpp v170, v170, v170 row_ror:2 row_mask:0xf bank_mask:0xf
    v_add_f32_dpp v171, v171, v171 row_ror:2 row_mask:0xf bank_mask:0xf
    v_add_f32_dpp v168, v168, v168 row_ror:1 row_mask:0xf bank_mask:0xf
    v_add_f32_dpp v169, v169, v169 row_ror:1 row_mask:0xf bank_mask:0xf
    v_add_f32_dpp v170, v170, v170 row_ror:1 row_mask:0xf bank_mask:0xf
    v_add_f32_dpp v171, v171, v171 row_ror:1 row_mask:0xf bank_mask:0xf
    v_cndmask_b32 v168, v169, v168, vcc
    v_cndmask_b32 v170, v171, v170, vcc
    v_cndmask_b32 v168, v170, v168, s[56:57]
    v_cvt_pk_bf16_f32 v168, v168, v168
    v_and_b32 v168, 0xffff0000, v168
    v_mul_f32 v28, 0xbfb8aa3b, v168
    v_exp_f32 v28, v28
    v_ashrrev_i32 v26, 31, v168
    v_or_b32 v26, 0x80000000, v26
    v_add_f32 v28, 1.0, v28
    v_rcp_f32 v28, v28
    v_xor_b32 v26, v168, v26
    v_and_b32 v26, 0xffff0000, v26
    v_sub_u32 v6, 0x7ff, v24
    v_or_b32 v26, v26, v6
    v_cvt_pk_bf16_f32 v28, v28, v28
    v_and_b32 v28, 0xffff0000, v28
    v_mov_b32 v29, s26
    v_lshlrev_b32 v24, 3, v24
    s_mov_b32 exec_lo, 0
    v_mov_b32 v26, 0
    s_mov_b32 exec_lo, -1
    s_nop 1
    v_max_u32_dpp v26, v26, v26 quad_perm:[1,0,3,2] row_mask:0xf bank_mask:0xf
    s_nop 1
    v_max_u32_dpp v26, v26, v26 quad_perm:[2,3,0,1] row_mask:0xf bank_mask:0xf
    s_nop 1
    v_max_u32_dpp v26, v26, v26 row_half_mirror row_mask:0xf bank_mask:0xf
    s_nop 1
    v_max_u32_dpp v26, v26, v26 row_mirror row_mask:0xf bank_mask:0xf
    v_mov_b32 v25, v26
    s_nop 1
    v_permlane16_swap_b32 v25, v26
    s_nop 1
    v_max_u32 v26, v26, v25
    v_mov_b32 v25, v26
    s_nop 1
    v_permlane32_swap_b32 v25, v26
    s_nop 1
    v_max_u32 v26, v26, v25
    s_mov_b64 exec, 1
    s_lshl_b32 s53, s66, 3
    s_add_u32 s53, s53, 0x816000
    s_mov_b32 s55, 0x800000
    buffer_store_dwordx2 v[26:27], v7, s[32:35], s53 offen sc1
    s_mov_b32 exec_lo, 0
    s_mov_b32 exec_hi, 0x000f000f
    buffer_store_dwordx2 v[28:29], v24, s[32:35], s55 offen sc1
    s_mov_b64 exec, -1
TOUCH1:
P2_SETUP:
    s_and_b32 s51, s27, 3
    s_lshr_b32 s52, s27, 2
    s_lshl_b32 s53, s49, 2
    s_add_u32 s53, s53, s51
    s_lshl_b32 s54, s53, 17
    s_add_u32 s54, s54, 0x200000
    s_lshl_b32 s57, s52, 16
    s_mov_b32 s55, 0
    s_add_u32 s57, s57, s55
    s_and_b32 s57, s57, 0x1ffff
    v_mov_b32 v12, 0xdddddddd
    v_and_b32 v14, 27, v2
    v_cmp_eq_u32 vcc, 16, v14
    v_mov_b32 v15, 0x3f803f80
    s_mov_b32 s58, 0xffff
    s_mov_b32 s59, 0xffff
    v_cndmask_b32 v14, 0, v15, vcc
    v_mov_b32 v15, v14
    s_lshl_b32 s56, s51, 11
    s_lshl_b32 s55, s52, 10
    s_add_u32 s56, s56, s55
    s_add_u32 s56, s56, 0x25000
    v_add_u32 v13, s56, v3
    v_xor_b32 v1, 0x400, v13
    v_mov_b64 v[200:201], v[14:15]
    v_mov_b64 v[202:203], v[14:15]
    v_mov_b64 v[204:205], v[14:15]
    v_mov_b64 v[206:207], v[14:15]
    v_mov_b64 v[212:213], v[14:15]
    v_mov_b64 v[214:215], v[14:15]
    v_mov_b64 v[216:217], v[14:15]
    v_mov_b64 v[218:219], v[14:15]
    v_mov_b64 v[224:225], v[14:15]
    v_mov_b64 v[226:227], v[14:15]
    v_mov_b64 v[228:229], v[14:15]
    v_mov_b64 v[230:231], v[14:15]
    v_mov_b64 v[236:237], v[14:15]
    v_mov_b64 v[238:239], v[14:15]
    v_mov_b64 v[240:241], v[14:15]
    v_mov_b64 v[242:243], v[14:15]
    v_mov_b64 v[248:249], v[14:15]
    v_mov_b64 v[250:251], v[14:15]
    v_mov_b64 v[252:253], v[14:15]
    v_mov_b64 v[254:255], v[14:15]
    s_cmp_lg_u32 s27, 0
    s_cbranch_scc1 P2_BQ
    s_lshl_b32 s64, s49, 10
    s_add_u32 s64, s64, 0x820000
    v_and_b32 v4, 31, v2
    v_lshlrev_b32 v4, 5, v4
    s_mov_b32 s65, 262144
P2_POLL:
    buffer_load_dword v5, v4, s[32:35], s64 offen sc1
    s_sub_u32 s65, s65, 1
    s_cbranch_scc1 P2_BQ
    s_waitcnt vmcnt(0)
    v_cmp_ne_u32 vcc, s26, v5
    s_cbranch_vccz P2_BQ
    s_sleep 1
    s_branch P2_POLL
P2_BQ:
    s_waitcnt lgkmcnt(0)
    s_barrier
    s_add_u32 s64, s54, s57
    s_add_u32 s57, s57, 4096
    s_and_b32 s57, s57, 0x1ffff
    buffer_load_dwordx4 v[196:199], v3, s[32:35], s64 offen offset:0 sc1
    s_mov_b64 exec, s[58:59]
    buffer_load_dwordx4 v[200:203], v3, s[32:35], s64 offen offset:1024 sc1
    buffer_load_dwordx4 v[204:207], v3, s[32:35], s64 offen offset:1280 sc1
    s_mov_b64 exec, -1
    buffer_load_dwordx4 v[208:211], v3, s[32:35], s64 offen offset:2048 sc1
    s_mov_b64 exec, s[58:59]
    buffer_load_dwordx4 v[212:215], v3, s[32:35], s64 offen offset:3072 sc1
    buffer_load_dwordx4 v[216:219], v3, s[32:35], s64 offen offset:3328 sc1
    s_mov_b64 exec, -1
    s_add_u32 s64, s54, s57
    s_add_u32 s57, s57, 4096
    s_and_b32 s57, s57, 0x1ffff
    buffer_load_dwordx4 v[220:223], v3, s[32:35], s64 offen offset:0 sc1
    s_mov_b64 exec, s[58:59]
    buffer_load_dwordx4 v[224:227], v3, s[32:35], s64 offen offset:1024 sc1
    buffer_load_dwordx4 v[228:231], v3, s[32:35], s64 offen offset:1280 sc1
    s_mov_b64 exec, -1
    buffer_load_dwordx4 v[232:235], v3, s[32:35], s64 offen offset:2048 sc1
    s_mov_b64 exec, s[58:59]
    buffer_load_dwordx4 v[236:239], v3, s[32:35], s64 offen offset:3072 sc1
    buffer_load_dwordx4 v[240:243], v3, s[32:35], s64 offen offset:3328 sc1
    s_mov_b64 exec, -1
    ds_read_b128 v[4:7], v1
    ds_read_b128 v[8:11], v13
    s_mul_i32 s66, s27, 2560
    s_add_u32 s66, s66, 0x20000
    s_xor_b32 s65, s27, 4
    s_mul_i32 s65, s65, 2560
    s_add_u32 s65, s65, 0x20000
    v_add_u32 v14, s66, v3
    v_add_u32 v15, s65, v3
    v_lshlrev_b32 v1, 3, v2
    v_add_u32 v13, s65, v1
    v_add_u32 v1, s66, v1
    s_min_u32 s60, s29, 27
    s_mul_i32 s61, s28, 28
    s_add_u32 s60, s60, s61
    s_lshl_b32 s63, s27, 10
    v_lshrrev_b32 v113, 3, v2
    v_and_b32 v114, 7, v2
    v_lshlrev_b32 v115, 1, v113
    v_and_b32 v115, 4, v115
    v_xor_b32 v114, v114, v115
    v_lshlrev_b32 v114, 4, v114
    v_mul_u32_u24 v112, 3584, v113
    v_add_u32 v112, v112, v114
    v_lshl_add_u32 v113, v113, 10, v114
    s_lshl_b32 s70, s49, 7
    s_lshl_b32 s71, s27, 13
    s_add_u32 s70, s70, s71
    s_lshr_b32 s77, s27, 1
    s_cmp_gt_u32 s29, 27
    s_cselect_b32 s76, 0, s27
    s_cselect_b32 s77, 0, s77
    s_cselect_b32 s78, 0, 1
    s_cmp_gt_u32 s27, 3
    s_cselect_b32 s78, 0, s78
    s_lshl_b32 s61, s28, 3
    s_add_u32 s61, s61, s27
    s_mul_i32 s61, s61, 28672
    s_lshl_b32 s62, s29, 7
    s_add_u32 s61, s61, s62
    s_and_b32 s67, s27, 1
    s_lshl_b32 s68, s67, 9
    s_lshl_b32 s62, s60, 13
    s_add_u32 s62, s62, s68
    s_lshl_b32 s68, s67, 12
    s_add_u32 s68, s68, 0x14000
    v_lshrrev_b32 v118, 5, v2
    v_lshl_add_u32 v118, v118, 9, v3
    v_mov_b64 v[48:49], 0
    v_mov_b64 v[50:51], 0
    v_mov_b64 v[52:53], 0
    v_mov_b64 v[54:55], 0
    v_mov_b64 v[56:57], 0
    v_mov_b64 v[58:59], 0
    v_mov_b64 v[60:61], 0
    v_mov_b64 v[62:63], 0
    v_mov_b64 v[64:65], 0
    v_mov_b64 v[66:67], 0
    v_mov_b64 v[68:69], 0
    v_mov_b64 v[70:71], 0
    v_mov_b64 v[72:73], 0
    v_mov_b64 v[74:75], 0
    v_mov_b64 v[76:77], 0
    v_mov_b64 v[78:79], 0
    s_mov_b32 s36, s14
    s_mov_b32 s37, s15
    s_mov_b32 s38, 0x1c0000
    s_mov_b32 s39, 0x00020000
    s_mov_b32 s40, s16
    s_mov_b32 s41, s17
    s_mov_b32 s42, 0x1c0000
    s_mov_b32 s43, 0x00020000
    s_mov_b32 s44, s18
    s_mov_b32 s45, s19
    s_mov_b32 s46, 0x1c0000
    s_mov_b32 s47, 0x00020000
    s_mov_b32 s72, s8
    s_mov_b32 s73, s9
    s_mov_b32 s74, 0x80000
    s_mov_b32 s75, 0x00020000
    s_waitcnt vmcnt(9) lgkmcnt(0)
    v_mfma_f32_32x32x16_bf16 v[16:31], v[196:199], v[4:7], 0
    v_mfma_f32_32x32x16_bf16 v[32:47], v[196:199], v[8:11], 0
    s_nop 10
    v_max3_f32 v114, v16, v17, v18
    v_max3_f32 v114, v114, v19, v20
    v_max3_f32 v114, v114, v21, v22
    v_max3_f32 v114, v114, v23, v24
    v_max3_f32 v114, v114, v25, v26
    v_max3_f32 v114, v114, v27, v28
    v_max3_f32 v114, v114, v29, v30
    v_max_f32 v114, v114, v31
    v_mov_b32 v115, v114
    s_nop 1
    v_permlane32_swap_b32 v115, v114
    s_nop 1
    v_max_f32 v114, v114, v115
    v_mul_f32 v80, -1.0, v114
    v_mul_f32 v81, -1.0, v114
    v_mov_b64 v[82:83], v[80:81]
    v_mov_b64 v[84:85], v[80:81]
    v_mov_b64 v[86:87], v[80:81]
    v_mov_b64 v[88:89], v[80:81]
    v_mov_b64 v[90:91], v[80:81]
    v_mov_b64 v[92:93], v[80:81]
    v_mov_b64 v[94:95], v[80:81]
    s_nop 1
    v_mfma_f32_32x32x16_bf16 v[16:31], v[196:199], v[4:7], v[80:95]
    v_max3_f32 v116, v32, v33, v34
    v_max3_f32 v116, v116, v35, v36
    v_max3_f32 v116, v116, v37, v38
    v_max3_f32 v116, v116, v39, v40
    v_max3_f32 v116, v116, v41, v42
    v_max3_f32 v116, v116, v43, v44
    v_max3_f32 v116, v116, v45, v46
    v_max_f32 v116, v116, v47
    v_mov_b32 v117, v116
    s_nop 1
    v_permlane32_swap_b32 v117, v116
    s_nop 1
    v_max_f32 v116, v116, v117
    v_mul_f32 v96, -1.0, v116
    v_mul_f32 v97, -1.0, v116
    v_mov_b64 v[98:99], v[96:97]
    v_mov_b64 v[100:101], v[96:97]
    v_mov_b64 v[102:103], v[96:97]
    v_mov_b64 v[104:105], v[96:97]
    v_mov_b64 v[106:107], v[96:97]
    v_mov_b64 v[108:109], v[96:97]
    v_mov_b64 v[110:111], v[96:97]
    s_setprio 3
    v_exp_f32 v16, v16
    v_exp_f32 v17, v17
    s_add_u32 s64, s54, s57
    s_add_u32 s57, s57, 4096
    s_and_b32 s57, s57, 0x1ffff
    buffer_load_dwordx4 v[244:247], v3, s[32:35], s64 offen offset:0 sc1
    s_mov_b64 exec, s[58:59]
    buffer_load_dwordx4 v[248:251], v3, s[32:35], s64 offen offset:1024 sc1
    buffer_load_dwordx4 v[252:255], v3, s[32:35], s64 offen offset:1280 sc1
    s_mov_b64 exec, -1
    v_exp_f32 v18, v18
    v_exp_f32 v19, v19
    v_exp_f32 v20, v20
    v_mfma_f32_32x32x16_bf16 v[32:47], v[196:199], v[8:11], v[96:111]
    v_exp_f32 v21, v21
    v_exp_f32 v22, v22
    v_exp_f32 v23, v23
    v_exp_f32 v24, v24
    v_exp_f32 v25, v25
    v_exp_f32 v26, v26
    v_smfmac_f32_32x32x32_bf16 v[48:63], v[200:203], v[16:23], v12
    v_exp_f32 v27, v27
    v_exp_f32 v28, v28
    v_exp_f32 v29, v29
    v_exp_f32 v30, v30
    v_exp_f32 v31, v31
    v_exp_f32 v32, v32
    v_exp_f32 v33, v33
    v_smfmac_f32_32x32x32_bf16 v[48:63], v[204:207], v[24:31], v12
    v_exp_f32 v34, v34
    v_exp_f32 v35, v35
    v_exp_f32 v36, v36
    s_waitcnt vmcnt(9)
    v_mfma_f32_32x32x16_bf16 v[16:31], v[208:211], v[4:7], v[80:95]
    v_exp_f32 v37, v37
    v_exp_f32 v38, v38
    v_exp_f32 v39, v39
    s_cmp_eq_u32 s78, 0
    s_cbranch_scc1 FWS0
    s_add_u32 m0, s63, 0x10000
    s_add_u32 s65, s61, 0
    buffer_load_dwordx4 v112, s[36:39], s65 offen lds
FWS0:
    v_exp_f32 v40, v40
    v_exp_f32 v41, v41
    v_exp_f32 v42, v42
    v_smfmac_f32_32x32x32_bf16 v[64:79], v[200:203], v[32:39], v12
    v_exp_f32 v43, v43
    v_exp_f32 v44, v44
    v_exp_f32 v45, v45
    v_exp_f32 v46, v46
    v_exp_f32 v47, v47
    v_exp_f32 v16, v16
    v_exp_f32 v17, v17
    v_smfmac_f32_32x32x32_bf16 v[64:79], v[204:207], v[40:47], v12
    buffer_load_dwordx4 v[196:199], v3, s[32:35], s64 offen offset:2048 sc1
    s_mov_b64 exec, s[58:59]
    buffer_load_dwordx4 v[200:203], v3, s[32:35], s64 offen offset:3072 sc1
    buffer_load_dwordx4 v[204:207], v3, s[32:35], s64 offen offset:3328 sc1
    s_mov_b64 exec, -1
    v_exp_f32 v18, v18
    v_exp_f32 v19, v19
    v_exp_f32 v20, v20
    v_mfma_f32_32x32x16_bf16 v[32:47], v[208:211], v[8:11], v[96:111]
    v_exp_f32 v21, v21
    v_exp_f32 v22, v22
    v_exp_f32 v23, v23
    s_cmp_lg_u32 s77, 3
    s_cbranch_scc1 FWD0
    s_add_u32 m0, s68, 0x0
    s_add_u32 s65, s62, 0
    buffer_load_dwordx4 v118, s[44:47], s65 offen lds
FWD0:
    v_exp_f32 v24, v24
    v_exp_f32 v25, v25
    v_exp_f32 v26, v26
    v_smfmac_f32_32x32x32_bf16 v[48:63], v[212:215], v[16:23], v12
    v_exp_f32 v27, v27
    v_exp_f32 v28, v28
    v_exp_f32 v29, v29
    v_exp_f32 v30, v30
    v_exp_f32 v31, v31
    v_exp_f32 v32, v32
    v_exp_f32 v33, v33
    v_smfmac_f32_32x32x32_bf16 v[48:63], v[216:219], v[24:31], v12
    v_exp_f32 v34, v34
    v_exp_f32 v35, v35
    v_exp_f32 v36, v36
    s_waitcnt vmcnt(9)
    v_mfma_f32_32x32x16_bf16 v[16:31], v[220:223], v[4:7], v[80:95]
    v_exp_f32 v37, v37
    v_exp_f32 v38, v38
    v_exp_f32 v39, v39
    v_exp_f32 v40, v40
    v_exp_f32 v41, v41
    v_exp_f32 v42, v42
    v_smfmac_f32_32x32x32_bf16 v[64:79], v[212:215], v[32:39], v12
    v_exp_f32 v43, v43
    v_exp_f32 v44, v44
    v_exp_f32 v45, v45
    v_exp_f32 v46, v46
    v_exp_f32 v47, v47
    v_exp_f32 v16, v16
    v_exp_f32 v17, v17
    v_smfmac_f32_32x32x32_bf16 v[64:79], v[216:219], v[40:47], v12
    s_add_u32 s64, s54, s57
    s_add_u32 s57, s57, 4096
    s_and_b32 s57, s57, 0x1ffff
    buffer_load_dwordx4 v[208:211], v3, s[32:35], s64 offen offset:0 sc1
    s_mov_b64 exec, s[58:59]
    buffer_load_dwordx4 v[212:215], v3, s[32:35], s64 offen offset:1024 sc1
    buffer_load_dwordx4 v[216:219], v3, s[32:35], s64 offen offset:1280 sc1
    s_mov_b64 exec, -1
    v_exp_f32 v18, v18
    v_exp_f32 v19, v19
    v_exp_f32 v20, v20
    v_mfma_f32_32x32x16_bf16 v[32:47], v[220:223], v[8:11], v[96:111]
    v_exp_f32 v21, v21
    v_exp_f32 v22, v22
    v_exp_f32 v23, v23
    s_cmp_eq_u32 s78, 0
    s_cbranch_scc1 FWS1
    s_add_u32 m0, s63, 0x12000
    s_add_u32 s65, s61, 0
    buffer_load_dwordx4 v112, s[40:43], s65 offen lds
FWS1:
    s_cmp_lg_u32 s77, 3
    s_cbranch_scc1 FWD1
    s_add_u32 m0, s68, 0x400
    s_add_u32 s65, s62, 2048
    buffer_load_dwordx4 v118, s[44:47], s65 offen lds
FWD1:
    v_exp_f32 v24, v24
    v_exp_f32 v25, v25
    v_exp_f32 v26, v26
    v_smfmac_f32_32x32x32_bf16 v[48:63], v[224:227], v[16:23], v12
    v_exp_f32 v27, v27
    v_exp_f32 v28, v28
    v_exp_f32 v29, v29
    v_exp_f32 v30, v30
    v_exp_f32 v31, v31
    v_exp_f32 v32, v32
    v_exp_f32 v33, v33
    v_smfmac_f32_32x32x32_bf16 v[48:63], v[228:231], v[24:31], v12
    v_exp_f32 v34, v34
    v_exp_f32 v35, v35
    v_exp_f32 v36, v36
    s_waitcnt vmcnt(9)
    v_mfma_f32_32x32x16_bf16 v[16:31], v[232:235], v[4:7], v[80:95]
    v_exp_f32 v37, v37
    v_exp_f32 v38, v38
    v_exp_f32 v39, v39
    s_cmp_eq_u32 s27, 1
    s_cbranch_scc1 FW_LD
FW_LD_RET:
    v_exp_f32 v40, v40
    v_exp_f32 v41, v41
    v_exp_f32 v42, v42
    v_smfmac_f32_32x32x32_bf16 v[64:79], v[224:227], v[32:39], v12
    v_exp_f32 v43, v43
    v_exp_f32 v44, v44
    v_exp_f32 v45, v45
    v_exp_f32 v46, v46
    v_exp_f32 v47, v47
    v_exp_f32 v16, v16
    v_exp_f32 v17, v17
    v_smfmac_f32_32x32x32_bf16 v[64:79], v[228:231], v[40:47], v12
    buffer_load_dwordx4 v[220:223], v3, s[32:35], s64 offen offset:2048 sc1
    s_mov_b64 exec, s[58:59]
    buffer_load_dwordx4 v[224:227], v3, s[32:35], s64 offen offset:3072 sc1
    buffer_load_dwordx4 v[228:231], v3, s[32:35], s64 offen offset:3328 sc1
    s_mov_b64 exec, -1
    v_exp_f32 v18, v18
    v_exp_f32 v19, v19
    v_exp_f32 v20, v20
    v_mfma_f32_32x32x16_bf16 v[32:47], v[232:235], v[8:11], v[96:111]
    v_exp_f32 v21, v21
    v_exp_f32 v22, v22
    v_exp_f32 v23, v23
    s_cmp_lg_u32 s77, 3
    s_cbranch_scc1 FWD2
    s_add_u32 m0, s68, 0x800
    s_add_u32 s65, s62, 4096
    buffer_load_dwordx4 v118, s[44:47], s65 offen lds
FWD2:
    v_exp_f32 v24, v24
    v_exp_f32 v25, v25
    v_exp_f32 v26, v26
    v_smfmac_f32_32x32x32_bf16 v[48:63], v[236:239], v[16:23], v12
    v_exp_f32 v27, v27
    v_exp_f32 v28, v28
    v_exp_f32 v29, v29
    v_exp_f32 v30, v30
    v_exp_f32 v31, v31
    v_exp_f32 v32, v32
    v_exp_f32 v33, v33
    v_smfmac_f32_32x32x32_bf16 v[48:63], v[240:243], v[24:31], v12
    v_exp_f32 v34, v34
    v_exp_f32 v35, v35
    v_exp_f32 v36, v36
    s_waitcnt vmcnt(9)
    v_mfma_f32_32x32x16_bf16 v[16:31], v[244:247], v[4:7], v[80:95]
    v_exp_f32 v37, v37
    v_exp_f32 v38, v38
    v_exp_f32 v39, v39
    s_cmp_eq_u32 s78, 0
    s_cbranch_scc1 FWS2
    s_add_u32 m0, s63, 0x11000
    s_add_u32 s65, s61, 114688
    buffer_load_dwordx4 v112, s[36:39], s65 offen lds
FWS2:
    v_exp_f32 v40, v40
    v_exp_f32 v41, v41
    v_exp_f32 v42, v42
    v_smfmac_f32_32x32x32_bf16 v[64:79], v[236:239], v[32:39], v12
    v_exp_f32 v43, v43
    v_exp_f32 v44, v44
    v_exp_f32 v45, v45
    v_exp_f32 v46, v46
    v_exp_f32 v47, v47
    v_exp_f32 v16, v16
    v_exp_f32 v17, v17
    v_smfmac_f32_32x32x32_bf16 v[64:79], v[240:243], v[40:47], v12
    s_add_u32 s64, s54, s57
    s_add_u32 s57, s57, 4096
    s_and_b32 s57, s57, 0x1ffff
    buffer_load_dwordx4 v[232:235], v3, s[32:35], s64 offen offset:0 sc1
    s_mov_b64 exec, s[58:59]
    buffer_load_dwordx4 v[236:239], v3, s[32:35], s64 offen offset:1024 sc1
    buffer_load_dwordx4 v[240:243], v3, s[32:35], s64 offen offset:1280 sc1
    s_mov_b64 exec, -1
    v_exp_f32 v18, v18
    v_exp_f32 v19, v19
    v_exp_f32 v20, v20
    v_mfma_f32_32x32x16_bf16 v[32:47], v[244:247], v[8:11], v[96:111]
    v_exp_f32 v21, v21
    v_exp_f32 v22, v22
    v_exp_f32 v23, v23
    s_cmp_lg_u32 s77, 3
    s_cbranch_scc1 FWD3
    s_add_u32 m0, s68, 0xc00
    s_add_u32 s65, s62, 6144
    buffer_load_dwordx4 v118, s[44:47], s65 offen lds
FWD3:
    v_exp_f32 v24, v24
    v_exp_f32 v25, v25
    v_exp_f32 v26, v26
    v_smfmac_f32_32x32x32_bf16 v[48:63], v[248:251], v[16:23], v12
    v_exp_f32 v27, v27
    v_exp_f32 v28, v28
    v_exp_f32 v29, v29
    v_exp_f32 v30, v30
    v_exp_f32 v31, v31
    v_exp_f32 v32, v32
    v_exp_f32 v33, v33
    v_smfmac_f32_32x32x32_bf16 v[48:63], v[252:255], v[24:31], v12
    v_exp_f32 v34, v34
    v_exp_f32 v35, v35
    v_exp_f32 v36, v36
    s_waitcnt vmcnt(9)
    v_mfma_f32_32x32x16_bf16 v[16:31], v[196:199], v[4:7], v[80:95]
    v_exp_f32 v37, v37
    v_exp_f32 v38, v38
    v_exp_f32 v39, v39
    v_exp_f32 v40, v40
    v_exp_f32 v41, v41
    v_exp_f32 v42, v42
    v_smfmac_f32_32x32x32_bf16 v[64:79], v[248:251], v[32:39], v12
    v_exp_f32 v43, v43
    v_exp_f32 v44, v44
    v_exp_f32 v45, v45
    v_exp_f32 v46, v46
    v_exp_f32 v47, v47
    v_exp_f32 v16, v16
    v_exp_f32 v17, v17
    v_smfmac_f32_32x32x32_bf16 v[64:79], v[252:255], v[40:47], v12
    buffer_load_dwordx4 v[244:247], v3, s[32:35], s64 offen offset:2048 sc1
    s_mov_b64 exec, s[58:59]
    buffer_load_dwordx4 v[248:251], v3, s[32:35], s64 offen offset:3072 sc1
    buffer_load_dwordx4 v[252:255], v3, s[32:35], s64 offen offset:3328 sc1
    s_mov_b64 exec, -1
    v_exp_f32 v18, v18
    v_exp_f32 v19, v19
    v_exp_f32 v20, v20
    v_mfma_f32_32x32x16_bf16 v[32:47], v[196:199], v[8:11], v[96:111]
    v_exp_f32 v21, v21
    v_exp_f32 v22, v22
    v_exp_f32 v23, v23
    s_cmp_eq_u32 s78, 0
    s_cbranch_scc1 FWS3
    s_add_u32 m0, s63, 0x13000
    s_add_u32 s65, s61, 114688
    buffer_load_dwordx4 v112, s[40:43], s65 offen lds
FWS3:
    v_exp_f32 v24, v24
    v_exp_f32 v25, v25
    v_exp_f32 v26, v26
    v_smfmac_f32_32x32x32_bf16 v[48:63], v[200:203], v[16:23], v12
    v_exp_f32 v27, v27
    v_exp_f32 v28, v28
    v_exp_f32 v29, v29
    v_exp_f32 v30, v30
    v_exp_f32 v31, v31
    v_exp_f32 v32, v32
    v_exp_f32 v33, v33
    v_smfmac_f32_32x32x32_bf16 v[48:63], v[204:207], v[24:31], v12
    v_exp_f32 v34, v34
    v_exp_f32 v35, v35
    v_exp_f32 v36, v36
    s_waitcnt vmcnt(9)
    v_mfma_f32_32x32x16_bf16 v[16:31], v[208:211], v[4:7], v[80:95]
    v_exp_f32 v37, v37
    v_exp_f32 v38, v38
    v_exp_f32 v39, v39
    v_exp_f32 v40, v40
    v_exp_f32 v41, v41
    v_exp_f32 v42, v42
    v_smfmac_f32_32x32x32_bf16 v[64:79], v[200:203], v[32:39], v12
    v_exp_f32 v43, v43
    v_exp_f32 v44, v44
    v_exp_f32 v45, v45
    v_exp_f32 v46, v46
    v_exp_f32 v47, v47
    v_exp_f32 v16, v16
    v_exp_f32 v17, v17
    v_smfmac_f32_32x32x32_bf16 v[64:79], v[204:207], v[40:47], v12
    s_add_u32 s64, s54, s57
    s_add_u32 s57, s57, 4096
    s_and_b32 s57, s57, 0x1ffff
    buffer_load_dwordx4 v[196:199], v3, s[32:35], s64 offen offset:0 sc1
    s_mov_b64 exec, s[58:59]
    buffer_load_dwordx4 v[200:203], v3, s[32:35], s64 offen offset:1024 sc1
    buffer_load_dwordx4 v[204:207], v3, s[32:35], s64 offen offset:1280 sc1
    s_mov_b64 exec, -1
    v_exp_f32 v18, v18
    v_exp_f32 v19, v19
    v_exp_f32 v20, v20
    v_mfma_f32_32x32x16_bf16 v[32:47], v[208:211], v[8:11], v[96:111]
    v_exp_f32 v21, v21
    v_exp_f32 v22, v22
    v_exp_f32 v23, v23
    v_exp_f32 v24, v24
    v_exp_f32 v25, v25
    v_exp_f32 v26, v26
    v_smfmac_f32_32x32x32_bf16 v[48:63], v[212:215], v[16:23], v12
    v_exp_f32 v27, v27
    v_exp_f32 v28, v28
    v_exp_f32 v29, v29
    v_exp_f32 v30, v30
    v_exp_f32 v31, v31
    v_exp_f32 v32, v32
    v_exp_f32 v33, v33
    v_smfmac_f32_32x32x32_bf16 v[48:63], v[216:219], v[24:31], v12
    v_exp_f32 v34, v34
    v_exp_f32 v35, v35
    v_exp_f32 v36, v36
    s_waitcnt vmcnt(9)
    v_mfma_f32_32x32x16_bf16 v[16:31], v[220:223], v[4:7], v[80:95]
    v_exp_f32 v37, v37
    v_exp_f32 v38, v38
    v_exp_f32 v39, v39
    v_exp_f32 v40, v40
    v_exp_f32 v41, v41
    v_exp_f32 v42, v42
    v_smfmac_f32_32x32x32_bf16 v[64:79], v[212:215], v[32:39], v12
    v_exp_f32 v43, v43
    v_exp_f32 v44, v44
    v_exp_f32 v45, v45
    v_exp_f32 v46, v46
    v_exp_f32 v47, v47
    v_exp_f32 v16, v16
    v_exp_f32 v17, v17
    v_smfmac_f32_32x32x32_bf16 v[64:79], v[216:219], v[40:47], v12
    buffer_load_dwordx4 v[208:211], v3, s[32:35], s64 offen offset:2048 sc1
    s_mov_b64 exec, s[58:59]
    buffer_load_dwordx4 v[212:215], v3, s[32:35], s64 offen offset:3072 sc1
    buffer_load_dwordx4 v[216:219], v3, s[32:35], s64 offen offset:3328 sc1
    s_mov_b64 exec, -1
    v_exp_f32 v18, v18
    v_exp_f32 v19, v19
    v_exp_f32 v20, v20
    v_mfma_f32_32x32x16_bf16 v[32:47], v[220:223], v[8:11], v[96:111]
    v_exp_f32 v21, v21
    v_exp_f32 v22, v22
    v_exp_f32 v23, v23
    v_exp_f32 v24, v24
    v_exp_f32 v25, v25
    v_exp_f32 v26, v26
    v_smfmac_f32_32x32x32_bf16 v[48:63], v[224:227], v[16:23], v12
    v_exp_f32 v27, v27
    v_exp_f32 v28, v28
    v_exp_f32 v29, v29
    v_exp_f32 v30, v30
    v_exp_f32 v31, v31
    v_exp_f32 v32, v32
    v_exp_f32 v33, v33
    v_smfmac_f32_32x32x32_bf16 v[48:63], v[228:231], v[24:31], v12
    v_exp_f32 v34, v34
    v_exp_f32 v35, v35
    v_exp_f32 v36, v36
    s_waitcnt vmcnt(9)
    v_mfma_f32_32x32x16_bf16 v[16:31], v[232:235], v[4:7], v[80:95]
    v_exp_f32 v37, v37
    v_exp_f32 v38, v38
    v_exp_f32 v39, v39
    s_cmp_eq_u32 s27, 1
    s_cbranch_scc1 FW_KEYS
FW_KEYS_RET:
    v_exp_f32 v40, v40
    v_exp_f32 v41, v41
    v_exp_f32 v42, v42
    v_smfmac_f32_32x32x32_bf16 v[64:79], v[224:227], v[32:39], v12
    v_exp_f32 v43, v43
    v_exp_f32 v44, v44
    v_exp_f32 v45, v45
    v_exp_f32 v46, v46
    v_exp_f32 v47, v47
    v_exp_f32 v16, v16
    v_exp_f32 v17, v17
    v_smfmac_f32_32x32x32_bf16 v[64:79], v[228:231], v[40:47], v12
    s_add_u32 s64, s54, s57
    s_add_u32 s57, s57, 4096
    s_and_b32 s57, s57, 0x1ffff
    buffer_load_dwordx4 v[220:223], v3, s[32:35], s64 offen offset:0 sc1
    s_mov_b64 exec, s[58:59]
    buffer_load_dwordx4 v[224:227], v3, s[32:35], s64 offen offset:1024 sc1
    buffer_load_dwordx4 v[228:231], v3, s[32:35], s64 offen offset:1280 sc1
    s_mov_b64 exec, -1
    v_exp_f32 v18, v18
    v_exp_f32 v19, v19
    v_exp_f32 v20, v20
    v_mfma_f32_32x32x16_bf16 v[32:47], v[232:235], v[8:11], v[96:111]
    v_exp_f32 v21, v21
    v_exp_f32 v22, v22
    v_exp_f32 v23, v23
    v_exp_f32 v24, v24
    v_exp_f32 v25, v25
    v_exp_f32 v26, v26
    v_smfmac_f32_32x32x32_bf16 v[48:63], v[236:239], v[16:23], v12
    v_exp_f32 v27, v27
    v_exp_f32 v28, v28
    v_exp_f32 v29, v29
    v_exp_f32 v30, v30
    v_exp_f32 v31, v31
    v_exp_f32 v32, v32
    v_exp_f32 v33, v33
    v_smfmac_f32_32x32x32_bf16 v[48:63], v[240:243], v[24:31], v12
    v_exp_f32 v34, v34
    v_exp_f32 v35, v35
    v_exp_f32 v36, v36
    s_waitcnt vmcnt(9)
    v_mfma_f32_32x32x16_bf16 v[16:31], v[244:247], v[4:7], v[80:95]
    v_exp_f32 v37, v37
    v_exp_f32 v38, v38
    v_exp_f32 v39, v39
    v_exp_f32 v40, v40
    v_exp_f32 v41, v41
    v_exp_f32 v42, v42
    v_smfmac_f32_32x32x32_bf16 v[64:79], v[236:239], v[32:39], v12
    v_exp_f32 v43, v43
    v_exp_f32 v44, v44
    v_exp_f32 v45, v45
    v_exp_f32 v46, v46
    v_exp_f32 v47, v47
    v_exp_f32 v16, v16
    v_exp_f32 v17, v17
    v_smfmac_f32_32x32x32_bf16 v[64:79], v[240:243], v[40:47], v12
    buffer_load_dwordx4 v[232:235], v3, s[32:35], s64 offen offset:2048 sc1
    s_mov_b64 exec, s[58:59]
    buffer_load_dwordx4 v[236:239], v3, s[32:35], s64 offen offset:3072 sc1
    buffer_load_dwordx4 v[240:243], v3, s[32:35], s64 offen offset:3328 sc1
    s_mov_b64 exec, -1
    v_exp_f32 v18, v18
    v_exp_f32 v19, v19
    v_exp_f32 v20, v20
    v_mfma_f32_32x32x16_bf16 v[32:47], v[244:247], v[8:11], v[96:111]
    v_exp_f32 v21, v21
    v_exp_f32 v22, v22
    v_exp_f32 v23, v23
    v_exp_f32 v24, v24
    v_exp_f32 v25, v25
    v_exp_f32 v26, v26
    v_smfmac_f32_32x32x32_bf16 v[48:63], v[248:251], v[16:23], v12
    v_exp_f32 v27, v27
    v_exp_f32 v28, v28
    v_exp_f32 v29, v29
    v_exp_f32 v30, v30
    v_exp_f32 v31, v31
    v_exp_f32 v32, v32
    v_exp_f32 v33, v33
    v_smfmac_f32_32x32x32_bf16 v[48:63], v[252:255], v[24:31], v12
    v_exp_f32 v34, v34
    v_exp_f32 v35, v35
    v_exp_f32 v36, v36
    s_waitcnt vmcnt(9)
    v_mfma_f32_32x32x16_bf16 v[16:31], v[196:199], v[4:7], v[80:95]
    v_exp_f32 v37, v37
    v_exp_f32 v38, v38
    v_exp_f32 v39, v39
    v_exp_f32 v40, v40
    v_exp_f32 v41, v41
    v_exp_f32 v42, v42
    v_smfmac_f32_32x32x32_bf16 v[64:79], v[248:251], v[32:39], v12
    v_exp_f32 v43, v43
    v_exp_f32 v44, v44
    v_exp_f32 v45, v45
    v_exp_f32 v46, v46
    v_exp_f32 v47, v47
    v_exp_f32 v16, v16
    v_exp_f32 v17, v17
    v_smfmac_f32_32x32x32_bf16 v[64:79], v[252:255], v[40:47], v12
    s_add_u32 s64, s54, s57
    s_add_u32 s57, s57, 4096
    s_and_b32 s57, s57, 0x1ffff
    buffer_load_dwordx4 v[244:247], v3, s[32:35], s64 offen offset:0 sc1
    s_mov_b64 exec, s[58:59]
    buffer_load_dwordx4 v[248:251], v3, s[32:35], s64 offen offset:1024 sc1
    buffer_load_dwordx4 v[252:255], v3, s[32:35], s64 offen offset:1280 sc1
    s_mov_b64 exec, -1
    v_exp_f32 v18, v18
    v_exp_f32 v19, v19
    v_exp_f32 v20, v20
    v_mfma_f32_32x32x16_bf16 v[32:47], v[196:199], v[8:11], v[96:111]
    v_exp_f32 v21, v21
    v_exp_f32 v22, v22
    v_exp_f32 v23, v23
    s_cmp_eq_u32 s78, 0
    s_cbranch_scc1 FWSC
    v_mov_b32 v114, 0x27004
    v_mov_b32 v115, 1
    s_mov_b64 exec, 1
    ds_add_u32 v114, v115
    s_mov_b64 exec, -1
FWSC:
    v_exp_f32 v24, v24
    v_exp_f32 v25, v25
    v_exp_f32 v26, v26
    v_smfmac_f32_32x32x32_bf16 v[48:63], v[200:203], v[16:23], v12
    v_exp_f32 v27, v27
    v_exp_f32 v28, v28
    v_exp_f32 v29, v29
    v_exp_f32 v30, v30
    v_exp_f32 v31, v31
    v_exp_f32 v32, v32
    v_exp_f32 v33, v33
    v_smfmac_f32_32x32x32_bf16 v[48:63], v[204:207], v[24:31], v12
    v_exp_f32 v34, v34
    v_exp_f32 v35, v35
    v_exp_f32 v36, v36
    s_waitcnt vmcnt(9)
    v_mfma_f32_32x32x16_bf16 v[16:31], v[208:211], v[4:7], v[80:95]
    v_exp_f32 v37, v37
    v_exp_f32 v38, v38
    v_exp_f32 v39, v39
    v_exp_f32 v40, v40
    v_exp_f32 v41, v41
    v_exp_f32 v42, v42
    v_smfmac_f32_32x32x32_bf16 v[64:79], v[200:203], v[32:39], v12
    v_exp_f32 v43, v43
    v_exp_f32 v44, v44
    v_exp_f32 v45, v45
    v_exp_f32 v46, v46
    v_exp_f32 v47, v47
    v_exp_f32 v16, v16
    v_exp_f32 v17, v17
    v_smfmac_f32_32x32x32_bf16 v[64:79], v[204:207], v[40:47], v12
    buffer_load_dwordx4 v[196:199], v3, s[32:35], s64 offen offset:2048 sc1
    s_mov_b64 exec, s[58:59]
    buffer_load_dwordx4 v[200:203], v3, s[32:35], s64 offen offset:3072 sc1
    buffer_load_dwordx4 v[204:207], v3, s[32:35], s64 offen offset:3328 sc1
    s_mov_b64 exec, -1
    v_exp_f32 v18, v18
    v_exp_f32 v19, v19
    v_exp_f32 v20, v20
    v_mfma_f32_32x32x16_bf16 v[32:47], v[208:211], v[8:11], v[96:111]
    v_exp_f32 v21, v21
    v_exp_f32 v22, v22
    v_exp_f32 v23, v23
    v_exp_f32 v24, v24
    v_exp_f32 v25, v25
    v_exp_f32 v26, v26
    v_smfmac_f32_32x32x32_bf16 v[48:63], v[212:215], v[16:23], v12
    v_exp_f32 v27, v27
    v_exp_f32 v28, v28
    v_exp_f32 v29, v29
    v_exp_f32 v30, v30
    v_exp_f32 v31, v31
    v_exp_f32 v32, v32
    v_exp_f32 v33, v33
    v_smfmac_f32_32x32x32_bf16 v[48:63], v[216:219], v[24:31], v12
    v_exp_f32 v34, v34
    v_exp_f32 v35, v35
    v_exp_f32 v36, v36
    s_waitcnt vmcnt(9)
    v_mfma_f32_32x32x16_bf16 v[16:31], v[220:223], v[4:7], v[80:95]
    v_exp_f32 v37, v37
    v_exp_f32 v38, v38
    v_exp_f32 v39, v39
    v_exp_f32 v40, v40
    v_exp_f32 v41, v41
    v_exp_f32 v42, v42
    v_smfmac_f32_32x32x32_bf16 v[64:79], v[212:215], v[32:39], v12
    v_exp_f32 v43, v43
    v_exp_f32 v44, v44
    v_exp_f32 v45, v45
    v_exp_f32 v46, v46
    v_exp_f32 v47, v47
    v_exp_f32 v16, v16
    v_exp_f32 v17, v17
    v_smfmac_f32_32x32x32_bf16 v[64:79], v[216:219], v[40:47], v12
    s_add_u32 s64, s54, s57
    s_add_u32 s57, s57, 4096
    s_and_b32 s57, s57, 0x1ffff
    buffer_load_dwordx4 v[208:211], v3, s[32:35], s64 offen offset:0 sc1
    s_mov_b64 exec, s[58:59]
    buffer_load_dwordx4 v[212:215], v3, s[32:35], s64 offen offset:1024 sc1
    buffer_load_dwordx4 v[216:219], v3, s[32:35], s64 offen offset:1280 sc1
    s_mov_b64 exec, -1
    v_exp_f32 v18, v18
    v_exp_f32 v19, v19
    v_exp_f32 v20, v20
    v_mfma_f32_32x32x16_bf16 v[32:47], v[220:223], v[8:11], v[96:111]
    v_exp_f32 v21, v21
    v_exp_f32 v22, v22
    v_exp_f32 v23, v23
    s_cmp_eq_u32 s77, 3
    s_cbranch_scc1 FW_S2A
FW_S2A_RET:
    v_exp_f32 v24, v24
    v_exp_f32 v25, v25
    v_exp_f32 v26, v26
    v_smfmac_f32_32x32x32_bf16 v[48:63], v[224:227], v[16:23], v12
    v_exp_f32 v27, v27
    v_exp_f32 v28, v28
    v_exp_f32 v29, v29
    v_exp_f32 v30, v30
    v_exp_f32 v31, v31
    v_exp_f32 v32, v32
    v_exp_f32 v33, v33
    v_smfmac_f32_32x32x32_bf16 v[48:63], v[228:231], v[24:31], v12
    v_exp_f32 v34, v34
    v_exp_f32 v35, v35
    v_exp_f32 v36, v36
    s_waitcnt vmcnt(9)
    v_mfma_f32_32x32x16_bf16 v[16:31], v[232:235], v[4:7], v[80:95]
    v_exp_f32 v37, v37
    v_exp_f32 v38, v38
    v_exp_f32 v39, v39
    s_cmp_eq_u32 s76, 1
    s_cbranch_scc1 FW_S1
FW_S1_RET:
    v_exp_f32 v40, v40
    v_exp_f32 v41, v41
    v_exp_f32 v42, v42
    v_smfmac_f32_32x32x32_bf16 v[64:79], v[224:227], v[32:39], v12
    v_exp_f32 v43, v43
    v_exp_f32 v44, v44
    v_exp_f32 v45, v45
    v_exp_f32 v46, v46
    v_exp_f32 v47, v47
    v_exp_f32 v16, v16
    v_exp_f32 v17, v17
    v_smfmac_f32_32x32x32_bf16 v[64:79], v[228:231], v[40:47], v12
    buffer_load_dwordx4 v[220:223], v3, s[32:35], s64 offen offset:2048 sc1
    s_mov_b64 exec, s[58:59]
    buffer_load_dwordx4 v[224:227], v3, s[32:35], s64 offen offset:3072 sc1
    buffer_load_dwordx4 v[228:231], v3, s[32:35], s64 offen offset:3328 sc1
    s_mov_b64 exec, -1
    v_exp_f32 v18, v18
    v_exp_f32 v19, v19
    v_exp_f32 v20, v20
    v_mfma_f32_32x32x16_bf16 v[32:47], v[232:235], v[8:11], v[96:111]
    v_exp_f32 v21, v21
    v_exp_f32 v22, v22
    v_exp_f32 v23, v23
    v_exp_f32 v24, v24
    v_exp_f32 v25, v25
    v_exp_f32 v26, v26
    v_smfmac_f32_32x32x32_bf16 v[48:63], v[236:239], v[16:23], v12
    v_exp_f32 v27, v27
    v_exp_f32 v28, v28
    v_exp_f32 v29, v29
    v_exp_f32 v30, v30
    v_exp_f32 v31, v31
    v_exp_f32 v32, v32
    v_exp_f32 v33, v33
    v_smfmac_f32_32x32x32_bf16 v[48:63], v[240:243], v[24:31], v12
    v_exp_f32 v34, v34
    v_exp_f32 v35, v35
    v_exp_f32 v36, v36
    s_waitcnt vmcnt(9)
    v_mfma_f32_32x32x16_bf16 v[16:31], v[244:247], v[4:7], v[80:95]
    v_exp_f32 v37, v37
    v_exp_f32 v38, v38
    v_exp_f32 v39, v39
    s_add_u32 m0, s63, 0x0
    s_add_u32 s65, s70, 0x0
    buffer_load_dwordx4 v113, s[72:75], s65 offen lds
    v_exp_f32 v40, v40
    v_exp_f32 v41, v41
    v_exp_f32 v42, v42
    v_smfmac_f32_32x32x32_bf16 v[64:79], v[236:239], v[32:39], v12
    v_exp_f32 v43, v43
    v_exp_f32 v44, v44
    v_exp_f32 v45, v45
    v_exp_f32 v46, v46
    v_exp_f32 v47, v47
    v_exp_f32 v16, v16
    v_exp_f32 v17, v17
    v_smfmac_f32_32x32x32_bf16 v[64:79], v[240:243], v[40:47], v12
    s_add_u32 s64, s54, s57
    s_add_u32 s57, s57, 4096
    s_and_b32 s57, s57, 0x1ffff
    buffer_load_dwordx4 v[232:235], v3, s[32:35], s64 offen offset:0 sc1
    s_mov_b64 exec, s[58:59]
    buffer_load_dwordx4 v[236:239], v3, s[32:35], s64 offen offset:1024 sc1
    buffer_load_dwordx4 v[240:243], v3, s[32:35], s64 offen offset:1280 sc1
    s_mov_b64 exec, -1
    v_exp_f32 v18, v18
    v_exp_f32 v19, v19
    v_exp_f32 v20, v20
    v_mfma_f32_32x32x16_bf16 v[32:47], v[244:247], v[8:11], v[96:111]
    v_exp_f32 v21, v21
    v_exp_f32 v22, v22
    v_exp_f32 v23, v23
    v_exp_f32 v24, v24
    v_exp_f32 v25, v25
    v_exp_f32 v26, v26
    v_smfmac_f32_32x32x32_bf16 v[48:63], v[248:251], v[16:23], v12
    v_exp_f32 v27, v27
    v_exp_f32 v28, v28
    v_exp_f32 v29, v29
    v_exp_f32 v30, v30
    v_exp_f32 v31, v31
    v_exp_f32 v32, v32
    v_exp_f32 v33, v33
    v_smfmac_f32_32x32x32_bf16 v[48:63], v[252:255], v[24:31], v12
    v_exp_f32 v34, v34
    v_exp_f32 v35, v35
    v_exp_f32 v36, v36
    s_waitcnt vmcnt(10)
    v_mfma_f32_32x32x16_bf16 v[16:31], v[196:199], v[4:7], v[80:95]
    v_exp_f32 v37, v37
    v_exp_f32 v38, v38
    v_exp_f32 v39, v39
    v_exp_f32 v40, v40
    v_exp_f32 v41, v41
    v_exp_f32 v42, v42
    v_smfmac_f32_32x32x32_bf16 v[64:79], v[248:251], v[32:39], v12
    v_exp_f32 v43, v43
    v_exp_f32 v44, v44
    v_exp_f32 v45, v45
    v_exp_f32 v46, v46
    v_exp_f32 v47, v47
    v_exp_f32 v16, v16
    v_exp_f32 v17, v17
    v_smfmac_f32_32x32x32_bf16 v[64:79], v[252:255], v[40:47], v12
    buffer_load_dwordx4 v[244:247], v3, s[32:35], s64 offen offset:2048 sc1
    s_mov_b64 exec, s[58:59]
    buffer_load_dwordx4 v[248:251], v3, s[32:35], s64 offen offset:3072 sc1
    buffer_load_dwordx4 v[252:255], v3, s[32:35], s64 offen offset:3328 sc1
    s_mov_b64 exec, -1
    v_exp_f32 v18, v18
    v_exp_f32 v19, v19
    v_exp_f32 v20, v20
    v_mfma_f32_32x32x16_bf16 v[32:47], v[196:199], v[8:11], v[96:111]
    v_exp_f32 v21, v21
    v_exp_f32 v22, v22
    v_exp_f32 v23, v23
    v_exp_f32 v24, v24
    v_exp_f32 v25, v25
    v_exp_f32 v26, v26
    v_smfmac_f32_32x32x32_bf16 v[48:63], v[200:203], v[16:23], v12
    v_exp_f32 v27, v27
    v_exp_f32 v28, v28
    v_exp_f32 v29, v29
    v_exp_f32 v30, v30
    v_exp_f32 v31, v31
    v_exp_f32 v32, v32
    v_exp_f32 v33, v33
    v_smfmac_f32_32x32x32_bf16 v[48:63], v[204:207], v[24:31], v12
    v_exp_f32 v34, v34
    v_exp_f32 v35, v35
    v_exp_f32 v36, v36
    s_waitcnt vmcnt(10)
    v_mfma_f32_32x32x16_bf16 v[16:31], v[208:211], v[4:7], v[80:95]
    v_exp_f32 v37, v37
    v_exp_f32 v38, v38
    v_exp_f32 v39, v39
    s_add_u32 m0, s63, 0x2000
    s_add_u32 s65, s70, 0x10000
    buffer_load_dwordx4 v113, s[72:75], s65 offen lds
    v_exp_f32 v40, v40
    v_exp_f32 v41, v41
    v_exp_f32 v42, v42
    v_smfmac_f32_32x32x32_bf16 v[64:79], v[200:203], v[32:39], v12
    v_exp_f32 v43, v43
    v_exp_f32 v44, v44
    v_exp_f32 v45, v45
    v_exp_f32 v46, v46
    v_exp_f32 v47, v47
    v_exp_f32 v16, v16
    v_exp_f32 v17, v17
    v_smfmac_f32_32x32x32_bf16 v[64:79], v[204:207], v[40:47], v12
    s_add_u32 s64, s54, s57
    s_add_u32 s57, s57, 4096
    s_and_b32 s57, s57, 0x1ffff
    buffer_load_dwordx4 v[196:199], v3, s[32:35], s64 offen offset:0 sc1
    s_mov_b64 exec, s[58:59]
    buffer_load_dwordx4 v[200:203], v3, s[32:35], s64 offen offset:1024 sc1
    buffer_load_dwordx4 v[204:207], v3, s[32:35], s64 offen offset:1280 sc1
    s_mov_b64 exec, -1
    v_exp_f32 v18, v18
    v_exp_f32 v19, v19
    v_exp_f32 v20, v20
    v_mfma_f32_32x32x16_bf16 v[32:47], v[208:211], v[8:11], v[96:111]
    v_exp_f32 v21, v21
    v_exp_f32 v22, v22
    v_exp_f32 v23, v23
    s_cmp_eq_u32 s77, 3
    s_cbranch_scc1 FW_S2
FW_S2_RET:
    v_exp_f32 v24, v24
    v_exp_f32 v25, v25
    v_exp_f32 v26, v26
    v_smfmac_f32_32x32x32_bf16 v[48:63], v[212:215], v[16:23], v12
    v_exp_f32 v27, v27
    v_exp_f32 v28, v28
    v_exp_f32 v29, v29
    v_exp_f32 v30, v30
    v_exp_f32 v31, v31
    v_exp_f32 v32, v32
    v_exp_f32 v33, v33
    v_smfmac_f32_32x32x32_bf16 v[48:63], v[216:219], v[24:31], v12
    v_exp_f32 v34, v34
    v_exp_f32 v35, v35
    v_exp_f32 v36, v36
    s_waitcnt vmcnt(11)
    v_mfma_f32_32x32x16_bf16 v[16:31], v[220:223], v[4:7], v[80:95]
    v_exp_f32 v37, v37
    v_exp_f32 v38, v38
    v_exp_f32 v39, v39
    v_exp_f32 v40, v40
    v_exp_f32 v41, v41
    v_exp_f32 v42, v42
    v_smfmac_f32_32x32x32_bf16 v[64:79], v[212:215], v[32:39], v12
    v_exp_f32 v43, v43
    v_exp_f32 v44, v44
    v_exp_f32 v45, v45
    v_exp_f32 v46, v46
    v_exp_f32 v47, v47
    v_exp_f32 v16, v16
    v_exp_f32 v17, v17
    v_smfmac_f32_32x32x32_bf16 v[64:79], v[216:219], v[40:47], v12
    buffer_load_dwordx4 v[208:211], v3, s[32:35], s64 offen offset:2048 sc1
    s_mov_b64 exec, s[58:59]
    buffer_load_dwordx4 v[212:215], v3, s[32:35], s64 offen offset:3072 sc1
    buffer_load_dwordx4 v[216:219], v3, s[32:35], s64 offen offset:3328 sc1
    s_mov_b64 exec, -1
    v_exp_f32 v18, v18
    v_exp_f32 v19, v19
    v_exp_f32 v20, v20
    v_mfma_f32_32x32x16_bf16 v[32:47], v[220:223], v[8:11], v[96:111]
    v_exp_f32 v21, v21
    v_exp_f32 v22, v22
    v_exp_f32 v23, v23
    v_exp_f32 v24, v24
    v_exp_f32 v25, v25
    v_exp_f32 v26, v26
    v_smfmac_f32_32x32x32_bf16 v[48:63], v[224:227], v[16:23], v12
    v_exp_f32 v27, v27
    v_exp_f32 v28, v28
    v_exp_f32 v29, v29
    v_exp_f32 v30, v30
    v_exp_f32 v31, v31
    v_exp_f32 v32, v32
    v_exp_f32 v33, v33
    v_smfmac_f32_32x32x32_bf16 v[48:63], v[228:231], v[24:31], v12
    v_exp_f32 v34, v34
    v_exp_f32 v35, v35
    v_exp_f32 v36, v36
    s_waitcnt vmcnt(10)
    v_mfma_f32_32x32x16_bf16 v[16:31], v[232:235], v[4:7], v[80:95]
    v_exp_f32 v37, v37
    v_exp_f32 v38, v38
    v_exp_f32 v39, v39
    s_add_u32 m0, s63, 0x4000
    s_add_u32 s65, s70, 0x20000
    buffer_load_dwordx4 v113, s[72:75], s65 offen lds
    v_exp_f32 v40, v40
    v_exp_f32 v41, v41
    v_exp_f32 v42, v42
    v_smfmac_f32_32x32x32_bf16 v[64:79], v[224:227], v[32:39], v12
    v_exp_f32 v43, v43
    v_exp_f32 v44, v44
    v_exp_f32 v45, v45
    v_exp_f32 v46, v46
    v_exp_f32 v47, v47
    s_setprio 2
    v_exp_f32 v16, v16
    v_exp_f32 v17, v17
    v_smfmac_f32_32x32x32_bf16 v[64:79], v[228:231], v[40:47], v12
    s_add_u32 s64, s54, s57
    s_add_u32 s57, s57, 4096
    s_and_b32 s57, s57, 0x1ffff
    buffer_load_dwordx4 v[220:223], v3, s[32:35], s64 offen offset:0 sc1
    s_mov_b64 exec, s[58:59]
    buffer_load_dwordx4 v[224:227], v3, s[32:35], s64 offen offset:1024 sc1
    buffer_load_dwordx4 v[228:231], v3, s[32:35], s64 offen offset:1280 sc1
    s_mov_b64 exec, -1
    v_exp_f32 v18, v18
    v_exp_f32 v19, v19
    v_exp_f32 v20, v20
    v_mfma_f32_32x32x16_bf16 v[32:47], v[232:235], v[8:11], v[96:111]
    v_exp_f32 v21, v21
    v_exp_f32 v22, v22
    v_exp_f32 v23, v23
    v_exp_f32 v24, v24
    v_exp_f32 v25, v25
    v_exp_f32 v26, v26
    v_smfmac_f32_32x32x32_bf16 v[48:63], v[236:239], v[16:23], v12
    v_exp_f32 v27, v27
    v_exp_f32 v28, v28
    v_exp_f32 v29, v29
    v_exp_f32 v30, v30
    v_exp_f32 v31, v31
    v_exp_f32 v32, v32
    v_exp_f32 v33, v33
    v_smfmac_f32_32x32x32_bf16 v[48:63], v[240:243], v[24:31], v12
    v_exp_f32 v34, v34
    v_exp_f32 v35, v35
    v_exp_f32 v36, v36
    s_waitcnt vmcnt(11)
    v_mfma_f32_32x32x16_bf16 v[16:31], v[244:247], v[4:7], v[80:95]
    v_exp_f32 v37, v37
    v_exp_f32 v38, v38
    v_exp_f32 v39, v39
    v_exp_f32 v40, v40
    v_exp_f32 v41, v41
    v_exp_f32 v42, v42
    v_smfmac_f32_32x32x32_bf16 v[64:79], v[236:239], v[32:39], v12
    v_exp_f32 v43, v43
    v_exp_f32 v44, v44
    v_exp_f32 v45, v45
    v_exp_f32 v46, v46
    v_exp_f32 v47, v47
    v_exp_f32 v16, v16
    v_exp_f32 v17, v17
    v_smfmac_f32_32x32x32_bf16 v[64:79], v[240:243], v[40:47], v12
    buffer_load_dwordx4 v[232:235], v3, s[32:35], s64 offen offset:2048 sc1
    s_mov_b64 exec, s[58:59]
    buffer_load_dwordx4 v[236:239], v3, s[32:35], s64 offen offset:3072 sc1
    buffer_load_dwordx4 v[240:243], v3, s[32:35], s64 offen offset:3328 sc1
    s_mov_b64 exec, -1
    v_exp_f32 v18, v18
    v_exp_f32 v19, v19
    v_exp_f32 v20, v20
    v_mfma_f32_32x32x16_bf16 v[32:47], v[244:247], v[8:11], v[96:111]
    v_exp_f32 v21, v21
    v_exp_f32 v22, v22
    v_exp_f32 v23, v23
    v_exp_f32 v24, v24
    v_exp_f32 v25, v25
    v_exp_f32 v26, v26
    v_smfmac_f32_32x32x32_bf16 v[48:63], v[248:251], v[16:23], v12
    v_exp_f32 v27, v27
    v_exp_f32 v28, v28
    v_exp_f32 v29, v29
    v_exp_f32 v30, v30
    v_exp_f32 v31, v31
    v_exp_f32 v32, v32
    v_exp_f32 v33, v33
    v_smfmac_f32_32x32x32_bf16 v[48:63], v[252:255], v[24:31], v12
    v_exp_f32 v34, v34
    v_exp_f32 v35, v35
    v_exp_f32 v36, v36
    s_waitcnt vmcnt(10)
    v_mfma_f32_32x32x16_bf16 v[16:31], v[196:199], v[4:7], v[80:95]
    v_exp_f32 v37, v37
    v_exp_f32 v38, v38
    v_exp_f32 v39, v39
    s_add_u32 m0, s63, 0x6000
    s_add_u32 s65, s70, 0x30000
    buffer_load_dwordx4 v113, s[72:75], s65 offen lds
    v_exp_f32 v40, v40
    v_exp_f32 v41, v41
    v_exp_f32 v42, v42
    v_smfmac_f32_32x32x32_bf16 v[64:79], v[248:251], v[32:39], v12
    v_exp_f32 v43, v43
    v_exp_f32 v44, v44
    v_exp_f32 v45, v45
    v_exp_f32 v46, v46
    v_exp_f32 v47, v47
    v_exp_f32 v16, v16
    v_exp_f32 v17, v17
    v_smfmac_f32_32x32x32_bf16 v[64:79], v[252:255], v[40:47], v12
    s_add_u32 s64, s54, s57
    s_add_u32 s57, s57, 4096
    s_and_b32 s57, s57, 0x1ffff
    buffer_load_dwordx4 v[244:247], v3, s[32:35], s64 offen offset:0 sc1
    s_mov_b64 exec, s[58:59]
    buffer_load_dwordx4 v[248:251], v3, s[32:35], s64 offen offset:1024 sc1
    buffer_load_dwordx4 v[252:255], v3, s[32:35], s64 offen offset:1280 sc1
    s_mov_b64 exec, -1
    v_exp_f32 v18, v18
    v_exp_f32 v19, v19
    v_exp_f32 v20, v20
    v_mfma_f32_32x32x16_bf16 v[32:47], v[196:199], v[8:11], v[96:111]
    v_exp_f32 v21, v21
    v_exp_f32 v22, v22
    v_exp_f32 v23, v23
    v_exp_f32 v24, v24
    v_exp_f32 v25, v25
    v_exp_f32 v26, v26
    v_smfmac_f32_32x32x32_bf16 v[48:63], v[200:203], v[16:23], v12
    v_exp_f32 v27, v27
    v_exp_f32 v28, v28
    v_exp_f32 v29, v29
    v_exp_f32 v30, v30
    v_exp_f32 v31, v31
    v_exp_f32 v32, v32
    v_exp_f32 v33, v33
    v_smfmac_f32_32x32x32_bf16 v[48:63], v[204:207], v[24:31], v12
    v_exp_f32 v34, v34
    v_exp_f32 v35, v35
    v_exp_f32 v36, v36
    s_waitcnt vmcnt(11)
    v_mfma_f32_32x32x16_bf16 v[16:31], v[208:211], v[4:7], v[80:95]
    v_exp_f32 v37, v37
    v_exp_f32 v38, v38
    v_exp_f32 v39, v39
    v_exp_f32 v40, v40
    v_exp_f32 v41, v41
    v_exp_f32 v42, v42
    v_smfmac_f32_32x32x32_bf16 v[64:79], v[200:203], v[32:39], v12
    v_exp_f32 v43, v43
    v_exp_f32 v44, v44
    v_exp_f32 v45, v45
    v_exp_f32 v46, v46
    v_exp_f32 v47, v47
    v_exp_f32 v16, v16
    v_exp_f32 v17, v17
    v_smfmac_f32_32x32x32_bf16 v[64:79], v[204:207], v[40:47], v12
    buffer_load_dwordx4 v[196:199], v3, s[32:35], s64 offen offset:2048 sc1
    s_mov_b64 exec, s[58:59]
    buffer_load_dwordx4 v[200:203], v3, s[32:35], s64 offen offset:3072 sc1
    buffer_load_dwordx4 v[204:207], v3, s[32:35], s64 offen offset:3328 sc1
    s_mov_b64 exec, -1
    v_exp_f32 v18, v18
    v_exp_f32 v19, v19
    v_exp_f32 v20, v20
    v_mfma_f32_32x32x16_bf16 v[32:47], v[208:211], v[8:11], v[96:111]
    v_exp_f32 v21, v21
    v_exp_f32 v22, v22
    v_exp_f32 v23, v23
    v_exp_f32 v24, v24
    v_exp_f32 v25, v25
    v_exp_f32 v26, v26
    v_smfmac_f32_32x32x32_bf16 v[48:63], v[212:215], v[16:23], v12
    v_exp_f32 v27, v27
    v_exp_f32 v28, v28
    v_exp_f32 v29, v29
    v_exp_f32 v30, v30
    v_exp_f32 v31, v31
    v_exp_f32 v32, v32
    v_exp_f32 v33, v33
    v_smfmac_f32_32x32x32_bf16 v[48:63], v[216:219], v[24:31], v12
    v_exp_f32 v34, v34
    v_exp_f32 v35, v35
    v_exp_f32 v36, v36
    s_waitcnt vmcnt(10)
    v_mfma_f32_32x32x16_bf16 v[16:31], v[220:223], v[4:7], v[80:95]
    v_exp_f32 v37, v37
    v_exp_f32 v38, v38
    v_exp_f32 v39, v39
    s_add_u32 m0, s63, 0x8000
    s_add_u32 s65, s70, 0x40000
    buffer_load_dwordx4 v113, s[72:75], s65 offen lds
    v_exp_f32 v40, v40
    v_exp_f32 v41, v41
    v_exp_f32 v42, v42
    v_smfmac_f32_32x32x32_bf16 v[64:79], v[212:215], v[32:39], v12
    v_exp_f32 v43, v43
    v_exp_f32 v44, v44
    v_exp_f32 v45, v45
    v_exp_f32 v46, v46
    v_exp_f32 v47, v47
    v_exp_f32 v16, v16
    v_exp_f32 v17, v17
    v_smfmac_f32_32x32x32_bf16 v[64:79], v[216:219], v[40:47], v12
    s_add_u32 s64, s54, s57
    s_add_u32 s57, s57, 4096
    s_and_b32 s57, s57, 0x1ffff
    buffer_load_dwordx4 v[208:211], v3, s[32:35], s64 offen offset:0 sc1
    s_mov_b64 exec, s[58:59]
    buffer_load_dwordx4 v[212:215], v3, s[32:35], s64 offen offset:1024 sc1
    buffer_load_dwordx4 v[216:219], v3, s[32:35], s64 offen offset:1280 sc1
    s_mov_b64 exec, -1
    v_exp_f32 v18, v18
    v_exp_f32 v19, v19
    v_exp_f32 v20, v20
    v_mfma_f32_32x32x16_bf16 v[32:47], v[220:223], v[8:11], v[96:111]
    v_exp_f32 v21, v21
    v_exp_f32 v22, v22
    v_exp_f32 v23, v23
    s_cmp_eq_u32 s77, 3
    s_cbranch_scc1 FW_F3
FW_F3_RET:
    v_exp_f32 v24, v24
    v_exp_f32 v25, v25
    v_exp_f32 v26, v26
    v_smfmac_f32_32x32x32_bf16 v[48:63], v[224:227], v[16:23], v12
    v_exp_f32 v27, v27
    v_exp_f32 v28, v28
    v_exp_f32 v29, v29
    v_exp_f32 v30, v30
    v_exp_f32 v31, v31
    v_exp_f32 v32, v32
    v_exp_f32 v33, v33
    v_smfmac_f32_32x32x32_bf16 v[48:63], v[228:231], v[24:31], v12
    v_exp_f32 v34, v34
    v_exp_f32 v35, v35
    v_exp_f32 v36, v36
    s_waitcnt vmcnt(11)
    v_mfma_f32_32x32x16_bf16 v[16:31], v[232:235], v[4:7], v[80:95]
    v_exp_f32 v37, v37
    v_exp_f32 v38, v38
    v_exp_f32 v39, v39
    v_exp_f32 v40, v40
    v_exp_f32 v41, v41
    v_exp_f32 v42, v42
    v_smfmac_f32_32x32x32_bf16 v[64:79], v[224:227], v[32:39], v12
    v_exp_f32 v43, v43
    v_exp_f32 v44, v44
    v_exp_f32 v45, v45
    v_exp_f32 v46, v46
    v_exp_f32 v47, v47
    v_exp_f32 v16, v16
    v_exp_f32 v17, v17
    v_smfmac_f32_32x32x32_bf16 v[64:79], v[228:231], v[40:47], v12
    buffer_load_dwordx4 v[220:223], v3, s[32:35], s64 offen offset:2048 sc1
    s_mov_b64 exec, s[58:59]
    buffer_load_dwordx4 v[224:227], v3, s[32:35], s64 offen offset:3072 sc1
    buffer_load_dwordx4 v[228:231], v3, s[32:35], s64 offen offset:3328 sc1
    s_mov_b64 exec, -1
    v_exp_f32 v18, v18
    v_exp_f32 v19, v19
    v_exp_f32 v20, v20
    v_mfma_f32_32x32x16_bf16 v[32:47], v[232:235], v[8:11], v[96:111]
    v_exp_f32 v21, v21
    v_exp_f32 v22, v22
    v_exp_f32 v23, v23
    v_exp_f32 v24, v24
    v_exp_f32 v25, v25
    v_exp_f32 v26, v26
    v_smfmac_f32_32x32x32_bf16 v[48:63], v[236:239], v[16:23], v12
    v_exp_f32 v27, v27
    v_exp_f32 v28, v28
    v_exp_f32 v29, v29
    v_exp_f32 v30, v30
    v_exp_f32 v31, v31
    v_exp_f32 v32, v32
    v_exp_f32 v33, v33
    v_smfmac_f32_32x32x32_bf16 v[48:63], v[240:243], v[24:31], v12
    v_exp_f32 v34, v34
    v_exp_f32 v35, v35
    v_exp_f32 v36, v36
    s_waitcnt vmcnt(10)
    v_mfma_f32_32x32x16_bf16 v[16:31], v[244:247], v[4:7], v[80:95]
    v_exp_f32 v37, v37
    v_exp_f32 v38, v38
    v_exp_f32 v39, v39
    s_add_u32 m0, s63, 0xa000
    s_add_u32 s65, s70, 0x50000
    buffer_load_dwordx4 v113, s[72:75], s65 offen lds
    v_exp_f32 v40, v40
    v_exp_f32 v41, v41
    v_exp_f32 v42, v42
    v_smfmac_f32_32x32x32_bf16 v[64:79], v[236:239], v[32:39], v12
    v_exp_f32 v43, v43
    v_exp_f32 v44, v44
    v_exp_f32 v45, v45
    v_exp_f32 v46, v46
    v_exp_f32 v47, v47
    v_exp_f32 v16, v16
    v_exp_f32 v17, v17
    v_smfmac_f32_32x32x32_bf16 v[64:79], v[240:243], v[40:47], v12
    s_add_u32 s64, s54, s57
    s_add_u32 s57, s57, 4096
    s_and_b32 s57, s57, 0x1ffff
    buffer_load_dwordx4 v[232:235], v3, s[32:35], s64 offen offset:0 sc1
    s_mov_b64 exec, s[58:59]
    buffer_load_dwordx4 v[236:239], v3, s[32:35], s64 offen offset:1024 sc1
    buffer_load_dwordx4 v[240:243], v3, s[32:35], s64 offen offset:1280 sc1
    s_mov_b64 exec, -1
    v_exp_f32 v18, v18
    v_exp_f32 v19, v19
    v_exp_f32 v20, v20
    v_mfma_f32_32x32x16_bf16 v[32:47], v[244:247], v[8:11], v[96:111]
    v_exp_f32 v21, v21
    v_exp_f32 v22, v22
    v_exp_f32 v23, v23
    v_exp_f32 v24, v24
    v_exp_f32 v25, v25
    v_exp_f32 v26, v26
    v_smfmac_f32_32x32x32_bf16 v[48:63], v[248:251], v[16:23], v12
    v_exp_f32 v27, v27
    v_exp_f32 v28, v28
    v_exp_f32 v29, v29
    v_exp_f32 v30, v30
    v_exp_f32 v31, v31
    v_exp_f32 v32, v32
    v_exp_f32 v33, v33
    v_smfmac_f32_32x32x32_bf16 v[48:63], v[252:255], v[24:31], v12
    v_exp_f32 v34, v34
    v_exp_f32 v35, v35
    v_exp_f32 v36, v36
    s_waitcnt vmcnt(11)
    v_mfma_f32_32x32x16_bf16 v[16:31], v[196:199], v[4:7], v[80:95]
    v_exp_f32 v37, v37
    v_exp_f32 v38, v38
    v_exp_f32 v39, v39
    v_exp_f32 v40, v40
    v_exp_f32 v41, v41
    v_exp_f32 v42, v42
    v_smfmac_f32_32x32x32_bf16 v[64:79], v[248:251], v[32:39], v12
    v_exp_f32 v43, v43
    v_exp_f32 v44, v44
    v_exp_f32 v45, v45
    v_exp_f32 v46, v46
    v_exp_f32 v47, v47
    v_exp_f32 v16, v16
    v_exp_f32 v17, v17
    v_smfmac_f32_32x32x32_bf16 v[64:79], v[252:255], v[40:47], v12
    buffer_load_dwordx4 v[244:247], v3, s[32:35], s64 offen offset:2048 sc1
    s_mov_b64 exec, s[58:59]
    buffer_load_dwordx4 v[248:251], v3, s[32:35], s64 offen offset:3072 sc1
    buffer_load_dwordx4 v[252:255], v3, s[32:35], s64 offen offset:3328 sc1
    s_mov_b64 exec, -1
    v_exp_f32 v18, v18
    v_exp_f32 v19, v19
    v_exp_f32 v20, v20
    v_mfma_f32_32x32x16_bf16 v[32:47], v[196:199], v[8:11], v[96:111]
    v_exp_f32 v21, v21
    s_lshl_b32 s55, s48, 1
    s_add_u32 s55, s55, s52
    s_lshl_b32 s55, s55, 5
    s_add_u32 s55, s55, s53
    s_lshl_b32 s56, s55, 10
    s_add_u32 s56, s56, 0x600000
    s_lshl_b32 s66, s48, 8
    s_add_u32 s66, s66, 0x840000
    s_lshl_b32 s55, s49, 5
    s_add_u32 s55, s55, s66
    s_mov_b32 s79, s66
    s_lshr_b32 s69, s49, 1
    v_mov_b64 v[114:115], -1
    v_mov_b64 v[116:117], -1
    buffer_store_dwordx4 v[114:117], v3, s[32:35], s56 offen sc1
    v_exp_f32 v22, v22
    v_exp_f32 v23, v23
    v_exp_f32 v24, v24
    v_exp_f32 v25, v25
    v_exp_f32 v26, v26
    v_smfmac_f32_32x32x32_bf16 v[48:63], v[200:203], v[16:23], v12
    v_exp_f32 v27, v27
    v_exp_f32 v28, v28
    v_exp_f32 v29, v29
    v_exp_f32 v30, v30
    v_exp_f32 v31, v31
    v_exp_f32 v32, v32
    v_exp_f32 v33, v33
    v_smfmac_f32_32x32x32_bf16 v[48:63], v[204:207], v[24:31], v12
    v_exp_f32 v34, v34
    v_exp_f32 v35, v35
    v_exp_f32 v36, v36
    s_waitcnt vmcnt(10)
    v_mfma_f32_32x32x16_bf16 v[16:31], v[208:211], v[4:7], v[80:95]
    v_exp_f32 v37, v37
    v_exp_f32 v38, v38
    v_exp_f32 v39, v39
    s_add_u32 m0, s63, 0xc000
    s_add_u32 s65, s70, 0x60000
    buffer_load_dwordx4 v113, s[72:75], s65 offen lds
    v_exp_f32 v40, v40
    v_exp_f32 v41, v41
    v_exp_f32 v42, v42
    v_smfmac_f32_32x32x32_bf16 v[64:79], v[200:203], v[32:39], v12
    v_exp_f32 v43, v43
    v_exp_f32 v44, v44
    v_exp_f32 v45, v45
    v_exp_f32 v46, v46
    v_exp_f32 v47, v47
    v_exp_f32 v16, v16
    v_exp_f32 v17, v17
    v_smfmac_f32_32x32x32_bf16 v[64:79], v[204:207], v[40:47], v12
    s_add_u32 s64, s54, s57
    s_add_u32 s57, s57, 4096
    s_and_b32 s57, s57, 0x1ffff
    buffer_load_dwordx4 v[196:199], v3, s[32:35], s64 offen offset:0 sc1
    s_mov_b64 exec, s[58:59]
    buffer_load_dwordx4 v[200:203], v3, s[32:35], s64 offen offset:1024 sc1
    buffer_load_dwordx4 v[204:207], v3, s[32:35], s64 offen offset:1280 sc1
    s_mov_b64 exec, -1
    v_exp_f32 v18, v18
    v_exp_f32 v19, v19
    v_exp_f32 v20, v20
    v_mfma_f32_32x32x16_bf16 v[32:47], v[208:211], v[8:11], v[96:111]
    v_exp_f32 v21, v21
    v_exp_f32 v22, v22
    v_exp_f32 v23, v23
    v_exp_f32 v24, v24
    v_exp_f32 v25, v25
    v_exp_f32 v26, v26
    v_smfmac_f32_32x32x32_bf16 v[48:63], v[212:215], v[16:23], v12
    v_exp_f32 v27, v27
    v_exp_f32 v28, v28
    v_exp_f32 v29, v29
    v_exp_f32 v30, v30
    v_exp_f32 v31, v31
    v_exp_f32 v32, v32
    v_exp_f32 v33, v33
    v_smfmac_f32_32x32x32_bf16 v[48:63], v[216:219], v[24:31], v12
    v_exp_f32 v34, v34
    v_exp_f32 v35, v35
    v_exp_f32 v36, v36
    s_waitcnt vmcnt(11)
    v_mfma_f32_32x32x16_bf16 v[16:31], v[220:223], v[4:7], v[80:95]
    v_exp_f32 v37, v37
    v_exp_f32 v38, v38
    v_exp_f32 v39, v39
    v_exp_f32 v40, v40
    v_exp_f32 v41, v41
    v_exp_f32 v42, v42
    v_smfmac_f32_32x32x32_bf16 v[64:79], v[212:215], v[32:39], v12
    v_exp_f32 v43, v43
    v_exp_f32 v44, v44
    v_exp_f32 v45, v45
    v_exp_f32 v46, v46
    v_exp_f32 v47, v47
    v_exp_f32 v16, v16
    v_exp_f32 v17, v17
    v_smfmac_f32_32x32x32_bf16 v[64:79], v[216:219], v[40:47], v12
    buffer_load_dwordx4 v[208:211], v3, s[32:35], s64 offen offset:2048 sc1
    s_mov_b64 exec, s[58:59]
    buffer_load_dwordx4 v[212:215], v3, s[32:35], s64 offen offset:3072 sc1
    buffer_load_dwordx4 v[216:219], v3, s[32:35], s64 offen offset:3328 sc1
    s_mov_b64 exec, -1
    v_exp_f32 v18, v18
    v_exp_f32 v19, v19
    v_exp_f32 v20, v20
    v_mfma_f32_32x32x16_bf16 v[32:47], v[220:223], v[8:11], v[96:111]
    v_exp_f32 v21, v21
    v_exp_f32 v22, v22
    v_exp_f32 v23, v23
    v_exp_f32 v24, v24
    v_exp_f32 v25, v25
    v_exp_f32 v26, v26
    v_smfmac_f32_32x32x32_bf16 v[48:63], v[224:227], v[16:23], v12
    v_exp_f32 v27, v27
    v_exp_f32 v28, v28
    v_exp_f32 v29, v29
    v_exp_f32 v30, v30
    v_exp_f32 v31, v31
    v_exp_f32 v32, v32
    v_exp_f32 v33, v33
    v_smfmac_f32_32x32x32_bf16 v[48:63], v[228:231], v[24:31], v12
    v_exp_f32 v34, v34
    v_exp_f32 v35, v35
    v_exp_f32 v36, v36
    s_waitcnt vmcnt(10)
    v_mfma_f32_32x32x16_bf16 v[16:31], v[232:235], v[4:7], v[80:95]
    v_exp_f32 v37, v37
    v_exp_f32 v38, v38
    v_exp_f32 v39, v39
    s_add_u32 m0, s63, 0xe000
    s_add_u32 s65, s70, 0x70000
    buffer_load_dwordx4 v113, s[72:75], s65 offen lds
    v_exp_f32 v40, v40
    v_exp_f32 v41, v41
    v_exp_f32 v42, v42
    v_smfmac_f32_32x32x32_bf16 v[64:79], v[224:227], v[32:39], v12
    v_exp_f32 v43, v43
    v_exp_f32 v44, v44
    v_exp_f32 v45, v45
    v_exp_f32 v46, v46
    v_exp_f32 v47, v47
    s_setprio 1
    v_exp_f32 v16, v16
    v_exp_f32 v17, v17
    v_smfmac_f32_32x32x32_bf16 v[64:79], v[228:231], v[40:47], v12
    v_exp_f32 v18, v18
    v_exp_f32 v19, v19
    v_exp_f32 v20, v20
    v_mfma_f32_32x32x16_bf16 v[32:47], v[232:235], v[8:11], v[96:111]
    v_exp_f32 v21, v21
    v_exp_f32 v22, v22
    v_exp_f32 v23, v23
    v_exp_f32 v24, v24
    v_exp_f32 v25, v25
    v_exp_f32 v26, v26
    v_smfmac_f32_32x32x32_bf16 v[48:63], v[236:239], v[16:23], v12
    v_exp_f32 v27, v27
    v_exp_f32 v28, v28
    v_exp_f32 v29, v29
    v_exp_f32 v30, v30
    v_exp_f32 v31, v31
    v_exp_f32 v32, v32
    v_exp_f32 v33, v33
    v_smfmac_f32_32x32x32_bf16 v[48:63], v[240:243], v[24:31], v12
    v_exp_f32 v34, v34
    v_exp_f32 v35, v35
    v_exp_f32 v36, v36
    s_waitcnt vmcnt(8)
    v_mfma_f32_32x32x16_bf16 v[16:31], v[244:247], v[4:7], v[80:95]
    v_exp_f32 v37, v37
    v_exp_f32 v38, v38
    v_exp_f32 v39, v39
    v_exp_f32 v40, v40
    v_exp_f32 v41, v41
    v_exp_f32 v42, v42
    v_smfmac_f32_32x32x32_bf16 v[64:79], v[236:239], v[32:39], v12
    v_exp_f32 v43, v43
    v_exp_f32 v44, v44
    v_exp_f32 v45, v45
    v_exp_f32 v46, v46
    v_exp_f32 v47, v47
    v_exp_f32 v16, v16
    v_exp_f32 v17, v17
    v_smfmac_f32_32x32x32_bf16 v[64:79], v[240:243], v[40:47], v12
    v_exp_f32 v18, v18
    v_exp_f32 v19, v19
    v_exp_f32 v20, v20
    v_mfma_f32_32x32x16_bf16 v[32:47], v[244:247], v[8:11], v[96:111]
    v_exp_f32 v21, v21
    v_exp_f32 v22, v22
    v_exp_f32 v23, v23
    v_exp_f32 v24, v24
    v_exp_f32 v25, v25
    v_exp_f32 v26, v26
    v_smfmac_f32_32x32x32_bf16 v[48:63], v[248:251], v[16:23], v12
    v_exp_f32 v27, v27
    v_exp_f32 v28, v28
    v_exp_f32 v29, v29
    v_exp_f32 v30, v30
    v_exp_f32 v31, v31
    v_exp_f32 v32, v32
    v_exp_f32 v33, v33
    v_smfmac_f32_32x32x32_bf16 v[48:63], v[252:255], v[24:31], v12
    v_exp_f32 v34, v34
    v_exp_f32 v35, v35
    v_exp_f32 v36, v36
    s_waitcnt vmcnt(4)
    v_mfma_f32_32x32x16_bf16 v[16:31], v[196:199], v[4:7], v[80:95]
    v_exp_f32 v37, v37
    v_exp_f32 v38, v38
    v_exp_f32 v39, v39
    v_exp_f32 v40, v40
    v_exp_f32 v41, v41
    v_exp_f32 v42, v42
    v_smfmac_f32_32x32x32_bf16 v[64:79], v[248:251], v[32:39], v12
    v_exp_f32 v43, v43
    v_exp_f32 v44, v44
    v_exp_f32 v45, v45
    v_exp_f32 v46, v46
    v_exp_f32 v47, v47
    v_exp_f32 v16, v16
    v_exp_f32 v17, v17
    v_smfmac_f32_32x32x32_bf16 v[64:79], v[252:255], v[40:47], v12
    v_exp_f32 v18, v18
    v_exp_f32 v19, v19
    v_exp_f32 v20, v20
    v_mfma_f32_32x32x16_bf16 v[32:47], v[196:199], v[8:11], v[96:111]
    v_exp_f32 v21, v21
    v_exp_f32 v22, v22
    v_exp_f32 v23, v23
    v_exp_f32 v24, v24
    v_exp_f32 v25, v25
    v_exp_f32 v26, v26
    v_smfmac_f32_32x32x32_bf16 v[48:63], v[200:203], v[16:23], v12
    v_exp_f32 v27, v27
    v_exp_f32 v28, v28
    v_exp_f32 v29, v29
    v_exp_f32 v30, v30
    v_exp_f32 v31, v31
    v_exp_f32 v32, v32
    v_exp_f32 v33, v33
    v_smfmac_f32_32x32x32_bf16 v[48:63], v[204:207], v[24:31], v12
    v_exp_f32 v34, v34
    v_exp_f32 v35, v35
    v_exp_f32 v36, v36
    s_waitcnt vmcnt(1)
    v_mfma_f32_32x32x16_bf16 v[16:31], v[208:211], v[4:7], v[80:95]
    v_exp_f32 v37, v37
    v_exp_f32 v38, v38
    v_exp_f32 v39, v39
    v_exp_f32 v40, v40
    v_exp_f32 v41, v41
    v_exp_f32 v42, v42
    v_smfmac_f32_32x32x32_bf16 v[64:79], v[200:203], v[32:39], v12
    v_exp_f32 v43, v43
    v_exp_f32 v44, v44
    v_exp_f32 v45, v45
    v_exp_f32 v46, v46
    v_exp_f32 v47, v47
    s_setprio 0
    v_exp_f32 v16, v16
    v_exp_f32 v17, v17
    v_smfmac_f32_32x32x32_bf16 v[64:79], v[204:207], v[40:47], v12
    v_exp_f32 v18, v18
    v_exp_f32 v19, v19
    v_exp_f32 v20, v20
    v_mfma_f32_32x32x16_bf16 v[32:47], v[208:211], v[8:11], v[96:111]
    v_exp_f32 v21, v21
    v_exp_f32 v22, v22
    v_exp_f32 v23, v23
    v_exp_f32 v24, v24
    v_exp_f32 v25, v25
    v_exp_f32 v26, v26
    v_smfmac_f32_32x32x32_bf16 v[48:63], v[212:215], v[16:23], v12
    v_exp_f32 v27, v27
    s_lshl_b32 s60, s69, 14
    s_lshl_b32 s61, s52, 13
    s_add_u32 s60, s60, s61
    s_and_b32 s61, s53, 7
    s_lshl_b32 s61, s61, 10
    s_add_u32 s60, s60, s61
    s_add_u32 s60, s60, 0x10000
    s_lshl_b32 s61, s69, 2
    s_add_u32 s61, s61, 0x27010
    v_exp_f32 v28, v28
    v_exp_f32 v29, v29
    v_exp_f32 v30, v30
    v_exp_f32 v31, v31
    v_exp_f32 v32, v32
    v_exp_f32 v33, v33
    v_smfmac_f32_32x32x32_bf16 v[48:63], v[216:219], v[24:31], v12
    v_exp_f32 v34, v34
    v_exp_f32 v35, v35
    v_exp_f32 v36, v36
    v_exp_f32 v37, v37
    v_exp_f32 v38, v38
    v_exp_f32 v39, v39
    v_exp_f32 v40, v40
    v_exp_f32 v41, v41
    v_exp_f32 v42, v42
    v_smfmac_f32_32x32x32_bf16 v[64:79], v[212:215], v[32:39], v12
    v_exp_f32 v43, v43
    v_exp_f32 v44, v44
    v_exp_f32 v45, v45
    v_mov_b32 v57, v80
    ds_write_b128 v14, v[48:51]
    ds_write_b128 v14, v[52:55] offset:1024
    ds_write_b64 v1, v[56:57] offset:2048
    v_exp_f32 v46, v46
    v_exp_f32 v47, v47
    s_nop 1
    v_smfmac_f32_32x32x32_bf16 v[64:79], v[216:219], v[40:47], v12
    s_waitcnt vmcnt(0) lgkmcnt(0)
    s_barrier
    ds_read_b64 v[24:25], v13 offset:2048
    ds_read_b128 v[16:19], v15
    ds_read_b128 v[20:23], v15 offset:1024
    v_add_u32 v4, s60, v3
    v_mov_b32 v5, s61
    v_mov_b32 v6, 1
    v_mov_b32 v120, s26
    v_mov_b32 v121, 0
    v_mov_b32 v122, 0x27024
    v_mov_b32 v123, 1
    s_waitcnt lgkmcnt(2)
    v_min_f32 v116, v96, v25
    v_sub_f32 v117, v116, v96
    v_sub_f32 v118, v116, v25
    v_exp_f32 v117, v117
    v_exp_f32 v118, v118
    v_add_f32 v119, v72, v24
    v_mul_f32 v72, v72, v117
    v_cmp_ngt_f32 vcc, 0x6f800000, v119
    v_fmac_f32 v72, v24, v118
    v_rcp_f32 v114, v72
    s_mov_b64 s[64:65], vcc
    v_mul_f32 v116, v117, v114
    v_mul_f32 v118, v118, v114
    s_waitcnt lgkmcnt(0)
    v_pk_mul_f32 v[64:65], v[64:65], v[116:117] op_sel_hi:[1,0]
    v_pk_mul_f32 v[66:67], v[66:67], v[116:117] op_sel_hi:[1,0]
    v_pk_mul_f32 v[68:69], v[68:69], v[116:117] op_sel_hi:[1,0]
    v_pk_mul_f32 v[70:71], v[70:71], v[116:117] op_sel_hi:[1,0]
    v_pk_fma_f32 v[64:65], v[16:17], v[118:119], v[64:65] op_sel_hi:[1,0,1]
    v_pk_fma_f32 v[66:67], v[18:19], v[118:119], v[66:67] op_sel_hi:[1,0,1]
    v_pk_fma_f32 v[68:69], v[20:21], v[118:119], v[68:69] op_sel_hi:[1,0,1]
    v_pk_fma_f32 v[70:71], v[22:23], v[118:119], v[70:71] op_sel_hi:[1,0,1]
    v_add_f32 v115, |v64|, |v65|
    v_add_f32 v116, |v66|, |v67|
    v_add_f32 v117, |v68|, |v69|
    v_add_f32 v118, |v70|, |v71|
    v_add_f32 v115, v115, v116
    v_add_f32 v117, v117, v118
    v_add_f32 v115, v115, v117
    v_cmp_ngt_f32 vcc, 0x7f800000, v115
    s_or_b64 vcc, vcc, s[64:65]
    s_cbranch_vccnz P2_FALLBACK
P2_STORE:
    v_cvt_pk_bf16_f32 v16, v64, v65
    v_cvt_pk_bf16_f32 v17, v66, v67
    v_cvt_pk_bf16_f32 v18, v68, v69
    v_cvt_pk_bf16_f32 v19, v70, v71
    buffer_store_dwordx4 v[16:19], v3, s[32:35], s56 offen sc1
    s_barrier
    s_cmp_lg_u32 s27, 0
    s_cbranch_scc1 P3_NOF2
    s_mov_b64 exec, 1
    buffer_store_dword v120, v121, s[32:35], s55 offen sc1
    s_mov_b64 exec, -1
P3_NOF2:
    s_add_u32 s55, s55, 0x10000
    ds_write_b128 v4, v[16:19]
    s_mov_b64 exec, 1
    ds_add_u32 v5, v6
    s_mov_b64 exec, -1
    s_cmp_lt_u32 s27, 4
    s_cbranch_scc1 P3_COMPUTE
    s_lshr_b32 s67, s51, 1
    v_and_b32 v4, 3, v2
    v_add_u32 v4, s69, v4
    v_and_b32 v4, 3, v4
    v_lshlrev_b32 v8, 2, v4
    v_lshl_add_u32 v4, v4, 1, s67
    v_lshlrev_b32 v4, 5, v4
    buffer_load_dword v5, v4, s[32:35], s79 offen sc1
    v_add_u32 v8, 0x27010, v8
    v_mov_b32 v6, 4
    s_and_b32 s70, s51, 1
    s_lshl_b32 s71, s48, 1
    s_add_u32 s71, s71, s70
    s_lshl_b32 s71, s71, 15
    s_lshl_b32 s68, s67, 12
    s_add_u32 s71, s71, s68
    s_add_u32 s71, s71, 0x600000
    s_lshl_b32 s70, s70, 13
    s_add_u32 s70, s70, s68
    s_add_u32 s70, s70, 0x10000
    s_and_b32 s65, s49, 1
    s_cmp_eq_u32 s65, s67
    s_cselect_b32 s62, 14, 15
    s_mov_b32 s63, 0
    s_mov_b32 s68, 262144
P3_POLL:
    s_waitcnt vmcnt(0)
    v_cmp_eq_u32 vcc, s26, v5
    s_mov_b32 exec_hi, 0
    s_mov_b32 exec_lo, s63
    ds_add_u32 v8, v6
    s_mov_b64 exec, -1
    s_sub_u32 s68, s68, 1
    s_cselect_b32 s64, 15, vcc_lo
    s_and_b32 s63, s64, s62
    s_andn2_b32 s62, s62, s63
    s_bitcmp1_b32 s63, 0
    s_cbranch_scc0 P3_NI0
    s_add_u32 s64, s69, 0
    s_and_b32 s64, s64, 3
    s_lshl_b32 s65, s64, 14
    s_add_u32 m0, s65, s70
    s_lshl_b32 s64, s64, 13
    s_add_u32 s64, s64, s71
    buffer_load_dwordx4 v3, s[32:35], s64 offen offset:0 sc1 lds
    buffer_load_dwordx4 v3, s[32:35], s64 offen offset:1024 sc1 lds
    buffer_load_dwordx4 v3, s[32:35], s64 offen offset:2048 sc1 lds
    buffer_load_dwordx4 v3, s[32:35], s64 offen offset:3072 sc1 lds
P3_NI0:
    s_bitcmp1_b32 s63, 1
    s_cbranch_scc0 P3_NI1
    s_add_u32 s64, s69, 1
    s_and_b32 s64, s64, 3
    s_lshl_b32 s65, s64, 14
    s_add_u32 m0, s65, s70
    s_lshl_b32 s64, s64, 13
    s_add_u32 s64, s64, s71
    buffer_load_dwordx4 v3, s[32:35], s64 offen offset:0 sc1 lds
    buffer_load_dwordx4 v3, s[32:35], s64 offen offset:1024 sc1 lds
    buffer_load_dwordx4 v3, s[32:35], s64 offen offset:2048 sc1 lds
    buffer_load_dwordx4 v3, s[32:35], s64 offen offset:3072 sc1 lds
P3_NI1:
    s_bitcmp1_b32 s63, 2
    s_cbranch_scc0 P3_NI2
    s_add_u32 s64, s69, 2
    s_and_b32 s64, s64, 3
    s_lshl_b32 s65, s64, 14
    s_add_u32 m0, s65, s70
    s_lshl_b32 s64, s64, 13
    s_add_u32 s64, s64, s71
    buffer_load_dwordx4 v3, s[32:35], s64 offen offset:0 sc1 lds
    buffer_load_dwordx4 v3, s[32:35], s64 offen offset:1024 sc1 lds
    buffer_load_dwordx4 v3, s[32:35], s64 offen offset:2048 sc1 lds
    buffer_load_dwordx4 v3, s[32:35], s64 offen offset:3072 sc1 lds
P3_NI2:
    s_bitcmp1_b32 s63, 3
    s_cbranch_scc0 P3_NI3
    s_add_u32 s64, s69, 3
    s_and_b32 s64, s64, 3
    s_lshl_b32 s65, s64, 14
    s_add_u32 m0, s65, s70
    s_lshl_b32 s64, s64, 13
    s_add_u32 s64, s64, s71
    buffer_load_dwordx4 v3, s[32:35], s64 offen offset:0 sc1 lds
    buffer_load_dwordx4 v3, s[32:35], s64 offen offset:1024 sc1 lds
    buffer_load_dwordx4 v3, s[32:35], s64 offen offset:2048 sc1 lds
    buffer_load_dwordx4 v3, s[32:35], s64 offen offset:3072 sc1 lds
P3_NI3:
    s_cmp_eq_u32 s62, 0
    s_cbranch_scc1 P3_LAST
    s_cmp_lg_u32 s63, 0
    s_cbranch_scc1 P3_NOSL
    s_sleep 2
P3_NOSL:
    buffer_load_dword v5, v4, s[32:35], s79 offen sc1
    s_branch P3_POLL
P3_LAST:
    s_mov_b32 exec_hi, 0
    s_cmp_lt_u32 s63, 14
    s_cbranch_scc1 P3_L0
    s_and_b32 exec_lo, s63, 1
    s_waitcnt vmcnt(12)
    ds_add_u32 v8, v6
    s_mov_b32 exec_lo, 2
    s_waitcnt vmcnt(8)
    ds_add_u32 v8, v6
    s_mov_b32 exec_lo, 4
    s_waitcnt vmcnt(4)
    ds_add_u32 v8, v6
    s_mov_b32 s63, 8
P3_L0:
    s_mov_b32 exec_lo, s63
    s_waitcnt vmcnt(0)
    ds_add_u32 v8, v6
    s_mov_b64 exec, 1
    ds_add_rtn_u32 v123, v122, v123
    s_waitcnt lgkmcnt(0)
    v_cmp_eq_u32 vcc, 7, v123
    s_cbranch_vccz P3_NB1
    buffer_store_dword v120, v121, s[32:35], s55 offen sc1
P3_NB1:
    s_mov_b64 exec, -1
    s_endpgm
P3_COMPUTE:
    s_and_b32 s70, s27, 1
    s_lshr_b32 s71, s27, 1
    v_lshrrev_b32 v4, 5, v2
    v_and_b32 v5, 31, v2
    s_lshl_b32 s66, s48, 6
    s_lshl_b32 s67, s70, 5
    s_add_u32 s66, s66, s67
    v_add_u32 v12, s66, v5
    s_lshl_b32 s67, s49, 6
    s_lshl_b32 s60, s71, 5
    s_add_u32 s67, s67, s60
    v_lshl_add_u32 v13, v4, 4, s67
    v_lshlrev_b32 v14, 10, v12
    v_lshl_add_u32 v14, v13, 1, v14
    v_lshlrev_b32 v15, 3, v12
    v_lshlrev_b32 v13, 2, v13
    v_mov_b32 v6, 0x27000
    ds_read_b32 v104, v6
    v_mul_u32_u24 v1, 12, v2
    s_mov_b32 s40, s4
    s_mov_b32 s41, s5
    s_mov_b32 s42, 0x200000
    s_mov_b32 s43, 0x00020000
    s_mov_b32 s60, 0x800000
    s_mov_b32 s61, 0x815000
    buffer_load_dwordx2 v[110:111], v15, s[32:35], s60 offen sc1
    buffer_load_dwordx4 v[80:83], v14, s[40:43], 0 offen
    buffer_load_dwordx4 v[84:87], v14, s[40:43], 0 offen offset:16
    buffer_load_dwordx4 v[124:127], v3, s[32:35], s61 offen sc1
    buffer_load_dwordx3 v[128:130], v1, s[32:35], s61 offen offset:1024 sc1
    s_mov_b32 s44, s22
    s_mov_b32 s45, s23
    s_mov_b32 s46, 0x200000
    s_mov_b32 s47, 0x00020000
    s_lshl_b32 s66, s70, 13
    s_add_u32 s66, s66, 0x10000
    v_add_u32 v10, s66, v3
    v_bfe_u32 v6, v2, 2, 2
    v_lshl_add_u32 v7, v4, 2, v6
    v_lshlrev_b32 v7, 7, v7
    v_lshrrev_b32 v6, 1, v6
    v_xor_b32 v6, s71, v6
    v_lshl_add_u32 v7, v6, 6, v7
    v_and_b32 v6, 1, v2
    v_lshl_add_u32 v7, v6, 5, v7
    v_bfe_u32 v6, v2, 4, 1
    v_lshl_add_u32 v7, v6, 4, v7
    v_bfe_u32 v6, v2, 1, 1
    v_lshl_add_u32 v11, v6, 3, v7
    v_mov_b64 v[64:65], 0
    v_mov_b64 v[66:67], 0
    v_mov_b64 v[68:69], 0
    v_mov_b64 v[70:71], 0
    v_mov_b64 v[72:73], 0
    v_mov_b64 v[74:75], 0
    v_mov_b64 v[76:77], 0
    v_mov_b64 v[78:79], 0
    s_waitcnt lgkmcnt(0)
    v_and_b32 v106, 0x7ff, v104
    v_sub_u32 v106, 0x7ff, v106
    v_cmp_eq_u32 s[76:77], v106, v12
    v_and_b32 v104, 0xffff0000, v104
    v_ashrrev_i32 v107, 31, v104
    v_not_b32 v107, v107
    v_or_b32 v107, 0x80000000, v107
    v_xor_b32 v104, v104, v107
    v_and_b32 v104, 0xffff0000, v104
    v_mul_f32 v104, 0xbfb8aa3b, v104
    v_exp_f32 v104, v104
    s_mov_b32 s68, 262144
    s_waitcnt vmcnt(2)
P3_GW:
    v_cmp_ne_u32 vcc, s26, v111
    s_cbranch_vccz P3_GOK
    s_sub_u32 s68, s68, 1
    s_cbranch_scc1 P3_GOK
    buffer_load_dwordx2 v[110:111], v15, s[32:35], s60 offen sc1
    s_waitcnt vmcnt(0)
    s_branch P3_GW
P3_GOK:
    v_mov_b32 v105, v110
    v_sub_f32 v108, 1.0, v110
    v_add_f32 v104, 1.0, v104
    v_rcp_f32 v104, v104
    v_lshlrev_b32 v48, 16, v80
    v_and_b32 v49, 0xffff0000, v80
    v_lshlrev_b32 v50, 16, v81
    v_and_b32 v51, 0xffff0000, v81
    v_lshlrev_b32 v52, 16, v82
    v_and_b32 v53, 0xffff0000, v82
    v_lshlrev_b32 v54, 16, v83
    v_and_b32 v55, 0xffff0000, v83
    v_lshlrev_b32 v56, 16, v84
    v_and_b32 v57, 0xffff0000, v84
    v_lshlrev_b32 v58, 16, v85
    v_and_b32 v59, 0xffff0000, v85
    v_lshlrev_b32 v60, 16, v86
    v_and_b32 v61, 0xffff0000, v86
    v_lshlrev_b32 v62, 16, v87
    v_and_b32 v63, 0xffff0000, v87
    s_cmp_eq_u64 s[76:77], 0
    s_cbranch_scc1 P3_NOSEL
    s_mov_b32 s68, 262144
P3_POLL3:
    s_waitcnt vmcnt(0)
    v_cmp_ne_u32 vcc, s26, v124
    v_cmp_ne_u32 s[64:65], s26, v125
    s_or_b64 vcc, vcc, s[64:65]
    v_cmp_ne_u32 s[64:65], s26, v126
    s_or_b64 vcc, vcc, s[64:65]
    v_cmp_ne_u32 s[64:65], s26, v127
    s_or_b64 vcc, vcc, s[64:65]
    v_cmp_ne_u32 s[64:65], s26, v128
    s_or_b64 vcc, vcc, s[64:65]
    v_cmp_ne_u32 s[64:65], s26, v129
    s_or_b64 vcc, vcc, s[64:65]
    v_cmp_ne_u32 s[64:65], s26, v130
    s_or_b64 vcc, vcc, s[64:65]
    s_cbranch_vccz P3_POLLED3
    s_sub_u32 s68, s68, 1
    s_cbranch_scc1 P3_POLLED3
    buffer_load_dwordx4 v[124:127], v3, s[32:35], s61 offen sc1
    buffer_load_dwordx3 v[128:130], v1, s[32:35], s61 offen offset:1024 sc1
    s_branch P3_POLL3
P3_POLLED3:
    s_mov_b32 s60, 0x860000
    v_lshl_add_u32 v6, v5, 11, v13
    buffer_load_dwordx4 v[88:91], v6, s[32:35], s60 offen offset:0 sc1
    buffer_load_dwordx4 v[92:95], v6, s[32:35], s60 offen offset:16 sc1
    buffer_load_dwordx4 v[96:99], v6, s[32:35], s60 offen offset:32 sc1
    buffer_load_dwordx4 v[100:103], v6, s[32:35], s60 offen offset:48 sc1
    s_waitcnt vmcnt(0)
    v_add_f32_dpp v88, v88, v88 row_ror:8 row_mask:0xf bank_mask:0xf
    v_add_f32_dpp v89, v89, v89 row_ror:8 row_mask:0xf bank_mask:0xf
    v_add_f32_dpp v90, v90, v90 row_ror:8 row_mask:0xf bank_mask:0xf
    v_add_f32_dpp v91, v91, v91 row_ror:8 row_mask:0xf bank_mask:0xf
    v_add_f32_dpp v92, v92, v92 row_ror:8 row_mask:0xf bank_mask:0xf
    v_add_f32_dpp v93, v93, v93 row_ror:8 row_mask:0xf bank_mask:0xf
    v_add_f32_dpp v94, v94, v94 row_ror:8 row_mask:0xf bank_mask:0xf
    v_add_f32_dpp v95, v95, v95 row_ror:8 row_mask:0xf bank_mask:0xf
    v_add_f32_dpp v96, v96, v96 row_ror:8 row_mask:0xf bank_mask:0xf
    v_add_f32_dpp v97, v97, v97 row_ror:8 row_mask:0xf bank_mask:0xf
    v_add_f32_dpp v98, v98, v98 row_ror:8 row_mask:0xf bank_mask:0xf
    v_add_f32_dpp v99, v99, v99 row_ror:8 row_mask:0xf bank_mask:0xf
    v_add_f32_dpp v100, v100, v100 row_ror:8 row_mask:0xf bank_mask:0xf
    v_add_f32_dpp v101, v101, v101 row_ror:8 row_mask:0xf bank_mask:0xf
    v_add_f32_dpp v102, v102, v102 row_ror:8 row_mask:0xf bank_mask:0xf
    v_add_f32_dpp v103, v103, v103 row_ror:8 row_mask:0xf bank_mask:0xf
    v_add_f32_dpp v88, v88, v88 row_ror:4 row_mask:0xf bank_mask:0xf
    v_add_f32_dpp v89, v89, v89 row_ror:4 row_mask:0xf bank_mask:0xf
    v_add_f32_dpp v90, v90, v90 row_ror:4 row_mask:0xf bank_mask:0xf
    v_add_f32_dpp v91, v91, v91 row_ror:4 row_mask:0xf bank_mask:0xf
    v_add_f32_dpp v92, v92, v92 row_ror:4 row_mask:0xf bank_mask:0xf
    v_add_f32_dpp v93, v93, v93 row_ror:4 row_mask:0xf bank_mask:0xf
    v_add_f32_dpp v94, v94, v94 row_ror:4 row_mask:0xf bank_mask:0xf
    v_add_f32_dpp v95, v95, v95 row_ror:4 row_mask:0xf bank_mask:0xf
    v_add_f32_dpp v96, v96, v96 row_ror:4 row_mask:0xf bank_mask:0xf
    v_add_f32_dpp v97, v97, v97 row_ror:4 row_mask:0xf bank_mask:0xf
    v_add_f32_dpp v98, v98, v98 row_ror:4 row_mask:0xf bank_mask:0xf
    v_add_f32_dpp v99, v99, v99 row_ror:4 row_mask:0xf bank_mask:0xf
    v_add_f32_dpp v100, v100, v100 row_ror:4 row_mask:0xf bank_mask:0xf
    v_add_f32_dpp v101, v101, v101 row_ror:4 row_mask:0xf bank_mask:0xf
    v_add_f32_dpp v102, v102, v102 row_ror:4 row_mask:0xf bank_mask:0xf
    v_add_f32_dpp v103, v103, v103 row_ror:4 row_mask:0xf bank_mask:0xf
    v_add_f32_dpp v88, v88, v88 row_ror:2 row_mask:0xf bank_mask:0xf
    v_add_f32_dpp v89, v89, v89 row_ror:2 row_mask:0xf bank_mask:0xf
    v_add_f32_dpp v90, v90, v90 row_ror:2 row_mask:0xf bank_mask:0xf
    v_add_f32_dpp v91, v91, v91 row_ror:2 row_mask:0xf bank_mask:0xf
    v_add_f32_dpp v92, v92, v92 row_ror:2 row_mask:0xf bank_mask:0xf
    v_add_f32_dpp v93, v93, v93 row_ror:2 row_mask:0xf bank_mask:0xf
    v_add_f32_dpp v94, v94, v94 row_ror:2 row_mask:0xf bank_mask:0xf
    v_add_f32_dpp v95, v95, v95 row_ror:2 row_mask:0xf bank_mask:0xf
    v_add_f32_dpp v96, v96, v96 row_ror:2 row_mask:0xf bank_mask:0xf
    v_add_f32_dpp v97, v97, v97 row_ror:2 row_mask:0xf bank_mask:0xf
    v_add_f32_dpp v98, v98, v98 row_ror:2 row_mask:0xf bank_mask:0xf
    v_add_f32_dpp v99, v99, v99 row_ror:2 row_mask:0xf bank_mask:0xf
    v_add_f32_dpp v100, v100, v100 row_ror:2 row_mask:0xf bank_mask:0xf
    v_add_f32_dpp v101, v101, v101 row_ror:2 row_mask:0xf bank_mask:0xf
    v_add_f32_dpp v102, v102, v102 row_ror:2 row_mask:0xf bank_mask:0xf
    v_add_f32_dpp v103, v103, v103 row_ror:2 row_mask:0xf bank_mask:0xf
    v_add_f32_dpp v88, v88, v88 row_ror:1 row_mask:0xf bank_mask:0xf
    v_add_f32_dpp v89, v89, v89 row_ror:1 row_mask:0xf bank_mask:0xf
    v_add_f32_dpp v90, v90, v90 row_ror:1 row_mask:0xf bank_mask:0xf
    v_add_f32_dpp v91, v91, v91 row_ror:1 row_mask:0xf bank_mask:0xf
    v_add_f32_dpp v92, v92, v92 row_ror:1 row_mask:0xf bank_mask:0xf
    v_add_f32_dpp v93, v93, v93 row_ror:1 row_mask:0xf bank_mask:0xf
    v_add_f32_dpp v94, v94, v94 row_ror:1 row_mask:0xf bank_mask:0xf
    v_add_f32_dpp v95, v95, v95 row_ror:1 row_mask:0xf bank_mask:0xf
    v_add_f32_dpp v96, v96, v96 row_ror:1 row_mask:0xf bank_mask:0xf
    v_add_f32_dpp v97, v97, v97 row_ror:1 row_mask:0xf bank_mask:0xf
    v_add_f32_dpp v98, v98, v98 row_ror:1 row_mask:0xf bank_mask:0xf
    v_add_f32_dpp v99, v99, v99 row_ror:1 row_mask:0xf bank_mask:0xf
    v_add_f32_dpp v100, v100, v100 row_ror:1 row_mask:0xf bank_mask:0xf
    v_add_f32_dpp v101, v101, v101 row_ror:1 row_mask:0xf bank_mask:0xf
    v_add_f32_dpp v102, v102, v102 row_ror:1 row_mask:0xf bank_mask:0xf
    v_add_f32_dpp v103, v103, v103 row_ror:1 row_mask:0xf bank_mask:0xf
    v_mov_b32 v16, v88
    v_mov_b32 v17, v89
    v_mov_b32 v18, v90
    v_mov_b32 v19, v91
    v_mov_b32 v20, v92
    v_mov_b32 v21, v93
    v_mov_b32 v22, v94
    v_mov_b32 v23, v95
    v_mov_b32 v24, v96
    v_mov_b32 v25, v97
    v_mov_b32 v26, v98
    v_mov_b32 v27, v99
    v_mov_b32 v28, v100
    v_mov_b32 v29, v101
    v_mov_b32 v30, v102
    v_mov_b32 v31, v103
    v_permlane16_swap_b32 v16, v88
    v_permlane16_swap_b32 v17, v89
    v_permlane16_swap_b32 v18, v90
    v_permlane16_swap_b32 v19, v91
    v_permlane16_swap_b32 v20, v92
    v_permlane16_swap_b32 v21, v93
    v_permlane16_swap_b32 v22, v94
    v_permlane16_swap_b32 v23, v95
    v_permlane16_swap_b32 v24, v96
    v_permlane16_swap_b32 v25, v97
    v_permlane16_swap_b32 v26, v98
    v_permlane16_swap_b32 v27, v99
    v_permlane16_swap_b32 v28, v100
    v_permlane16_swap_b32 v29, v101
    v_permlane16_swap_b32 v30, v102
    v_permlane16_swap_b32 v31, v103
    v_add_f32 v88, v88, v16
    v_add_f32 v89, v89, v17
    v_add_f32 v90, v90, v18
    v_add_f32 v91, v91, v19
    v_add_f32 v92, v92, v20
    v_add_f32 v93, v93, v21
    v_add_f32 v94, v94, v22
    v_add_f32 v95, v95, v23
    v_add_f32 v96, v96, v24
    v_add_f32 v97, v97, v25
    v_add_f32 v98, v98, v26
    v_add_f32 v99, v99, v27
    v_add_f32 v100, v100, v28
    v_add_f32 v101, v101, v29
    v_add_f32 v102, v102, v30
    v_add_f32 v103, v103, v31
    s_mov_b64 exec, s[76:77]
    v_fmac_f32 v48, v88, v104
    v_fmac_f32 v49, v89, v104
    v_fmac_f32 v50, v90, v104
    v_fmac_f32 v51, v91, v104
    v_fmac_f32 v52, v92, v104
    v_fmac_f32 v53, v93, v104
    v_fmac_f32 v54, v94, v104
    v_fmac_f32 v55, v95, v104
    v_fmac_f32 v56, v96, v104
    v_fmac_f32 v57, v97, v104
    v_fmac_f32 v58, v98, v104
    v_fmac_f32 v59, v99, v104
    v_fmac_f32 v60, v100, v104
    v_fmac_f32 v61, v101, v104
    v_fmac_f32 v62, v102, v104
    v_fmac_f32 v63, v103, v104
    s_mov_b64 exec, -1
P3_NOSEL:
    v_mul_f32 v48, v48, v108
    v_mul_f32 v49, v49, v108
    v_mul_f32 v50, v50, v108
    v_mul_f32 v51, v51, v108
    v_mul_f32 v52, v52, v108
    v_mul_f32 v53, v53, v108
    v_mul_f32 v54, v54, v108
    v_mul_f32 v55, v55, v108
    v_mul_f32 v56, v56, v108
    v_mul_f32 v57, v57, v108
    v_mul_f32 v58, v58, v108
    v_mul_f32 v59, v59, v108
    v_mul_f32 v60, v60, v108
    v_mul_f32 v61, v61, v108
    v_mul_f32 v62, v62, v108
    v_mul_f32 v63, v63, v108
    s_waitcnt vmcnt(0)
    s_mov_b64 exec, 1
    ds_add_rtn_u32 v123, v122, v123
    s_waitcnt lgkmcnt(0)
    v_cmp_eq_u32 vcc, 7, v123
    s_cbranch_vccz P3_NB2
    buffer_store_dword v120, v121, s[32:35], s55 offen sc1
P3_NB2:
    s_mov_b64 exec, -1
    s_mov_b32 s69, 15
    v_and_b32 v6, 3, v2
    v_lshlrev_b32 v6, 2, v6
    v_add_u32 v6, 0x27010, v6
P3_SPIN:
    ds_read_b32 v7, v6
    s_waitcnt lgkmcnt(0)
    v_cmp_eq_u32 vcc, 16, v7
    s_and_b32 s60, vcc_lo, s69
    s_cbranch_scc0 P3_SPIN
    s_ff1_i32_b32 s60, s60
    s_bitset0_b32 s69, s60
    s_lshl_b32 s60, s60, 14
    v_add_u32 v8, s60, v10
    v_add_u32 v9, s60, v11
    ds_read_b128 v[16:19], v8 offset:0
    ds_read_b64_tr_b16 v[20:21], v9 offset:0
    ds_read_b64_tr_b16 v[22:23], v9 offset:1024
    ds_read_b128 v[24:27], v8 offset:1024
    ds_read_b64_tr_b16 v[28:29], v9 offset:2048
    ds_read_b64_tr_b16 v[30:31], v9 offset:3072
    ds_read_b128 v[32:35], v8 offset:2048
    ds_read_b64_tr_b16 v[36:37], v9 offset:4096
    ds_read_b64_tr_b16 v[38:39], v9 offset:5120
    ds_read_b128 v[40:43], v8 offset:3072
    ds_read_b64_tr_b16 v[44:45], v9 offset:6144
    ds_read_b64_tr_b16 v[46:47], v9 offset:7168
P3_LOOP:
    s_waitcnt lgkmcnt(9)
    v_mfma_f32_32x32x16_bf16 v[64:79], v[20:23], v[16:19], v[64:79]
    ds_read_b32 v7, v6
    ds_read_b128 v[16:19], v8 offset:4096
    ds_read_b64_tr_b16 v[20:21], v9 offset:8192
    ds_read_b64_tr_b16 v[22:23], v9 offset:9216
    s_waitcnt lgkmcnt(10)
    v_mfma_f32_32x32x16_bf16 v[64:79], v[28:31], v[24:27], v[64:79]
    ds_read_b128 v[24:27], v8 offset:5120
    ds_read_b64_tr_b16 v[28:29], v9 offset:10240
    ds_read_b64_tr_b16 v[30:31], v9 offset:11264
    s_waitcnt lgkmcnt(10)
    v_mfma_f32_32x32x16_bf16 v[64:79], v[36:39], v[32:35], v[64:79]
    ds_read_b128 v[32:35], v8 offset:6144
    ds_read_b64_tr_b16 v[36:37], v9 offset:12288
    ds_read_b64_tr_b16 v[38:39], v9 offset:13312
    s_waitcnt lgkmcnt(10)
    v_mfma_f32_32x32x16_bf16 v[64:79], v[44:47], v[40:43], v[64:79]
    ds_read_b128 v[40:43], v8 offset:7168
    ds_read_b64_tr_b16 v[44:45], v9 offset:14336
    ds_read_b64_tr_b16 v[46:47], v9 offset:15360
    s_waitcnt lgkmcnt(9)
    v_cmp_eq_u32 vcc, 16, v7
    v_mfma_f32_32x32x16_bf16 v[64:79], v[20:23], v[16:19], v[64:79]
    s_and_b32 s60, vcc_lo, s69
    s_cbranch_scc0 P3_NONE
    s_ff1_i32_b32 s60, s60
    s_bitset0_b32 s69, s60
    s_lshl_b32 s60, s60, 14
    v_add_u32 v8, s60, v10
    v_add_u32 v9, s60, v11
    ds_read_b128 v[16:19], v8 offset:0
    ds_read_b64_tr_b16 v[20:21], v9 offset:0
    ds_read_b64_tr_b16 v[22:23], v9 offset:1024
    s_waitcnt lgkmcnt(9)
    v_mfma_f32_32x32x16_bf16 v[64:79], v[28:31], v[24:27], v[64:79]
    ds_read_b128 v[24:27], v8 offset:1024
    ds_read_b64_tr_b16 v[28:29], v9 offset:2048
    ds_read_b64_tr_b16 v[30:31], v9 offset:3072
    s_waitcnt lgkmcnt(9)
    v_mfma_f32_32x32x16_bf16 v[64:79], v[36:39], v[32:35], v[64:79]
    ds_read_b128 v[32:35], v8 offset:2048
    ds_read_b64_tr_b16 v[36:37], v9 offset:4096
    ds_read_b64_tr_b16 v[38:39], v9 offset:5120
    s_waitcnt lgkmcnt(9)
    v_mfma_f32_32x32x16_bf16 v[64:79], v[44:47], v[40:43], v[64:79]
    ds_read_b128 v[40:43], v8 offset:3072
    ds_read_b64_tr_b16 v[44:45], v9 offset:6144
    ds_read_b64_tr_b16 v[46:47], v9 offset:7168
    s_branch P3_LOOP
P3_NONE:
    s_waitcnt lgkmcnt(6)
    v_mfma_f32_32x32x16_bf16 v[64:79], v[28:31], v[24:27], v[64:79]
    s_waitcnt lgkmcnt(3)
    v_mfma_f32_32x32x16_bf16 v[64:79], v[36:39], v[32:35], v[64:79]
    s_waitcnt lgkmcnt(0)
    v_mfma_f32_32x32x16_bf16 v[64:79], v[44:47], v[40:43], v[64:79]
    s_cmp_lg_u32 s69, 0
    s_cbranch_scc1 P3_SPIN
    s_nop 10
    v_cmp_u_f32 vcc, v64, v64
    s_cbranch_vccnz P3_SLOW
P3_FIN:
    v_fmac_f32 v48, v64, v105
    v_fmac_f32 v49, v65, v105
    v_fmac_f32 v50, v66, v105
    v_fmac_f32 v51, v67, v105
    v_fmac_f32 v52, v68, v105
    v_fmac_f32 v53, v69, v105
    v_fmac_f32 v54, v70, v105
    v_fmac_f32 v55, v71, v105
    v_fmac_f32 v56, v72, v105
    v_fmac_f32 v57, v73, v105
    v_fmac_f32 v58, v74, v105
    v_fmac_f32 v59, v75, v105
    v_fmac_f32 v60, v76, v105
    v_fmac_f32 v61, v77, v105
    v_fmac_f32 v62, v78, v105
    v_fmac_f32 v63, v79, v105
    v_cvt_pk_bf16_f32 v80, v48, v49
    v_cvt_pk_bf16_f32 v81, v50, v51
    v_cvt_pk_bf16_f32 v82, v52, v53
    v_cvt_pk_bf16_f32 v83, v54, v55
    v_cvt_pk_bf16_f32 v84, v56, v57
    v_cvt_pk_bf16_f32 v85, v58, v59
    v_cvt_pk_bf16_f32 v86, v60, v61
    v_cvt_pk_bf16_f32 v87, v62, v63
    buffer_store_dwordx4 v[80:83], v14, s[44:47], 0 offen
    buffer_store_dwordx4 v[84:87], v14, s[44:47], 0 offen offset:16
    s_or_b32 s64, s2, s27
    s_cbranch_scc1 L_END
    s_mov_b32 s64, 0x818000
    s_mov_b64 exec, 1
    buffer_store_dword v120, v121, s[32:35], s64 offen sc1
L_END:
    s_endpgm
L_EXIT:
    s_endpgm
FW_LD:
    s_mov_b32 s79, 262144
    s_mov_b32 s65, 0x816000
    buffer_load_dwordx4 v[120:123], v3, s[32:35], s65 offen sc1
    buffer_load_dwordx4 v[124:127], v3, s[32:35], s65 offen offset:1024 sc1
    s_branch FW_LD_RET
FW_KEYRE:
    s_mov_b32 s65, 0x816000
    buffer_load_dwordx4 v[120:123], v3, s[32:35], s65 offen sc1
    buffer_load_dwordx4 v[124:127], v3, s[32:35], s65 offen offset:1024 sc1
    s_waitcnt vmcnt(0)
FW_KEYS:
    s_waitcnt vmcnt(12)
    v_cmp_ne_u32 vcc, s26, v121
    v_cmp_ne_u32 s[66:67], s26, v123
    s_or_b64 vcc, vcc, s[66:67]
    v_cmp_ne_u32 s[66:67], s26, v125
    s_or_b64 vcc, vcc, s[66:67]
    v_cmp_ne_u32 s[66:67], s26, v127
    s_or_b64 vcc, vcc, s[66:67]
    s_sub_u32 s79, s79, 1
    s_cbranch_scc1 FW_KEYOK
    s_cbranch_vccnz FW_KEYRE
FW_KEYOK:
    v_max3_u32 v120, v120, v122, v124
    v_max_u32 v120, v120, v126
    s_nop 1
    v_max_u32_dpp v120, v120, v120 quad_perm:[1,0,3,2] row_mask:0xf bank_mask:0xf
    s_nop 1
    v_max_u32_dpp v120, v120, v120 quad_perm:[2,3,0,1] row_mask:0xf bank_mask:0xf
    s_nop 1
    v_max_u32_dpp v120, v120, v120 row_half_mirror row_mask:0xf bank_mask:0xf
    s_nop 1
    v_max_u32_dpp v120, v120, v120 row_mirror row_mask:0xf bank_mask:0xf
    v_mov_b32 v121, v120
    s_nop 1
    v_permlane16_swap_b32 v121, v120
    s_nop 1
    v_max_u32 v120, v120, v121
    v_mov_b32 v121, v120
    s_nop 1
    v_permlane32_swap_b32 v121, v120
    s_nop 1
    v_max_u32 v120, v120, v121
    s_mov_b32 s96, s4
    s_mov_b32 s97, s5
    s_mov_b32 s98, 0x200000
    s_mov_b32 s99, 0x00020000
    v_readfirstlane_b32 s65, v120
    v_mov_b32 v121, 0x27000
    ds_write_b32 v121, v120
    v_lshrrev_b32 v116, 4, v2
    v_lshlrev_b32 v116, 4, v116
    s_and_b32 s65, s65, 0x7ff
    s_sub_u32 s65, 0x7ff, s65
    s_lshl_b32 s65, s65, 10
    s_lshl_b32 s66, s28, 7
    s_add_u32 s65, s65, s66
    buffer_load_dwordx4 v[180:183], v116, s[96:99], s65 offen
    buffer_load_dwordx4 v[184:187], v116, s[96:99], s65 offen offset:64
    s_branch FW_KEYS_RET
FW_S1:
    v_mov_b32 v116, 0x27004
    s_mov_b32 s79, 262144
FW_C1:
    ds_read_b32 v117, v116
    s_sub_u32 s79, s79, 1
    s_cbranch_scc1 FW_C1OK
    s_waitcnt lgkmcnt(0)
    v_cmp_ne_u32 vcc, 4, v117
    s_cbranch_vccz FW_C1OK
    s_sleep 2
    s_branch FW_C1
FW_C1OK:
    v_lshrrev_b32 v116, 4, v2
    v_bfe_u32 v117, v2, 2, 2
    v_lshl_add_u32 v116, v116, 3, v117
    v_lshlrev_b32 v116, 7, v116
    v_and_b32 v118, 3, v2
    v_lshl_add_u32 v116, v118, 3, v116
    v_lshrrev_b32 v117, 1, v117
    v_lshl_add_u32 v116, v117, 6, v116
    v_add_u32 v116, 0x10000, v116
    v_xor_b32 v117, 64, v116
    s_waitcnt vmcnt(12)
    ds_read_b64_tr_b16 v[120:121], v116 offset:0
    ds_read_b64_tr_b16 v[122:123], v116 offset:512
    ds_read_b64_tr_b16 v[124:125], v116 offset:32
    ds_read_b64_tr_b16 v[126:127], v116 offset:544
    ds_read_b64_tr_b16 v[128:129], v117 offset:0
    ds_read_b64_tr_b16 v[130:131], v117 offset:512
    ds_read_b64_tr_b16 v[132:133], v117 offset:32
    ds_read_b64_tr_b16 v[134:135], v117 offset:544
    s_waitcnt lgkmcnt(6)
    v_mfma_f32_16x16x32_bf16 v[148:151], v[180:183], v[120:123], 0
    s_waitcnt lgkmcnt(4)
    v_mfma_f32_16x16x32_bf16 v[152:155], v[180:183], v[124:127], 0
    s_waitcnt lgkmcnt(2)
    v_mfma_f32_16x16x32_bf16 v[156:159], v[180:183], v[128:131], 0
    s_waitcnt lgkmcnt(0)
    v_mfma_f32_16x16x32_bf16 v[160:163], v[180:183], v[132:135], 0
    ds_read_b64_tr_b16 v[120:121], v116 offset:4096
    ds_read_b64_tr_b16 v[122:123], v116 offset:4608
    ds_read_b64_tr_b16 v[124:125], v116 offset:4128
    ds_read_b64_tr_b16 v[126:127], v116 offset:4640
    ds_read_b64_tr_b16 v[128:129], v117 offset:4096
    ds_read_b64_tr_b16 v[130:131], v117 offset:4608
    ds_read_b64_tr_b16 v[132:133], v117 offset:4128
    ds_read_b64_tr_b16 v[134:135], v117 offset:4640
    s_waitcnt lgkmcnt(6)
    v_mfma_f32_16x16x32_bf16 v[148:151], v[184:187], v[120:123], v[148:151]
    s_waitcnt lgkmcnt(4)
    v_mfma_f32_16x16x32_bf16 v[152:155], v[184:187], v[124:127], v[152:155]
    s_waitcnt lgkmcnt(2)
    v_mfma_f32_16x16x32_bf16 v[156:159], v[184:187], v[128:131], v[156:159]
    s_waitcnt lgkmcnt(0)
    v_mfma_f32_16x16x32_bf16 v[160:163], v[184:187], v[132:135], v[160:163]
    ds_read_b64_tr_b16 v[120:121], v116 offset:8192
    ds_read_b64_tr_b16 v[122:123], v116 offset:8704
    ds_read_b64_tr_b16 v[124:125], v116 offset:8224
    ds_read_b64_tr_b16 v[126:127], v116 offset:8736
    ds_read_b64_tr_b16 v[128:129], v117 offset:8192
    ds_read_b64_tr_b16 v[130:131], v117 offset:8704
    ds_read_b64_tr_b16 v[132:133], v117 offset:8224
    ds_read_b64_tr_b16 v[134:135], v117 offset:8736
    s_waitcnt lgkmcnt(6)
    v_mfma_f32_16x16x32_bf16 v[164:167], v[180:183], v[120:123], 0
    s_waitcnt lgkmcnt(4)
    v_mfma_f32_16x16x32_bf16 v[168:171], v[180:183], v[124:127], 0
    s_waitcnt lgkmcnt(2)
    v_mfma_f32_16x16x32_bf16 v[172:175], v[180:183], v[128:131], 0
    s_waitcnt lgkmcnt(0)
    v_mfma_f32_16x16x32_bf16 v[176:179], v[180:183], v[132:135], 0
    ds_read_b64_tr_b16 v[120:121], v116 offset:12288
    ds_read_b64_tr_b16 v[122:123], v116 offset:12800
    ds_read_b64_tr_b16 v[124:125], v116 offset:12320
    ds_read_b64_tr_b16 v[126:127], v116 offset:12832
    ds_read_b64_tr_b16 v[128:129], v117 offset:12288
    ds_read_b64_tr_b16 v[130:131], v117 offset:12800
    ds_read_b64_tr_b16 v[132:133], v117 offset:12320
    ds_read_b64_tr_b16 v[134:135], v117 offset:12832
    s_waitcnt lgkmcnt(6)
    v_mfma_f32_16x16x32_bf16 v[164:167], v[184:187], v[120:123], v[164:167]
    s_waitcnt lgkmcnt(4)
    v_mfma_f32_16x16x32_bf16 v[168:171], v[184:187], v[124:127], v[168:171]
    s_waitcnt lgkmcnt(2)
    v_mfma_f32_16x16x32_bf16 v[172:175], v[184:187], v[128:131], v[172:175]
    s_waitcnt lgkmcnt(0)
    v_mfma_f32_16x16x32_bf16 v[176:179], v[184:187], v[132:135], v[176:179]
    v_lshlrev_b32 v116, 7, v2
    s_lshl_b32 s65, s29, 13
    s_lshl_b32 s66, s28, 4
    s_add_u32 s65, s65, s66
    s_add_u32 s65, s65, 0x880000
    s_nop 3
    v_mov_b32 v149, v164
    v_mov_b32 v150, s26
    s_mov_b32 exec_lo, 0xffff0000
    s_mov_b32 exec_hi, 0x0
    v_mov_b32 v148, v152
    v_mov_b32 v149, v168
    s_mov_b32 exec_lo, 0x0
    s_mov_b32 exec_hi, 0xffff
    v_mov_b32 v148, v156
    v_mov_b32 v149, v172
    s_mov_b32 exec_lo, 0x0
    s_mov_b32 exec_hi, 0xffff0000
    v_mov_b32 v148, v160
    v_mov_b32 v149, v176
    s_mov_b64 exec, -1
    buffer_store_dwordx4 v[148:151], v116, s[32:35], s65 offen sc1
    s_branch FW_S1_RET
FW_S2A:
    s_mov_b32 s79, 262144
    s_lshl_b32 s65, s60, 10
    s_add_u32 s65, s65, 0x880000
    buffer_load_dwordx4 v[152:155], v3, s[32:35], s65 offen sc1
    s_lshl_b32 s66, s27, 8
    s_add_u32 s66, s66, 0x15a00
    v_lshl_add_u32 v116, v2, 2, s66
    v_mov_b32 v117, 0
    ds_write_b32 v116, v117
    s_branch FW_S2A_RET
FW_S2RE:
    s_sleep 8
    s_lshl_b32 s65, s60, 10
    s_add_u32 s65, s65, 0x880000
    buffer_load_dwordx4 v[152:155], v3, s[32:35], s65 offen sc1
    s_waitcnt vmcnt(0)
FW_S2:
    s_waitcnt vmcnt(12)
    v_cmp_ne_u32 vcc, s26, v154
    s_sub_u32 s79, s79, 1
    s_cbranch_scc1 FW_S2OK
    s_cbranch_vccnz FW_S2RE
FW_S2OK:
    v_bfe_u32 v118, v2, 2, 3
    v_lshlrev_b32 v118, 9, v118
    v_and_b32 v119, 3, v2
    v_lshl_add_u32 v118, v119, 3, v118
    v_add_u32 v118, s68, v118
    v_add_f32_dpp v152, v152, v152 quad_perm:[1,0,3,2] row_mask:0xf bank_mask:0xf
    v_add_f32_dpp v153, v153, v153 quad_perm:[1,0,3,2] row_mask:0xf bank_mask:0xf
    ds_read_b64_tr_b16 v[120:121], v118 offset:0
    ds_read_b64_tr_b16 v[122:123], v118 offset:32
    ds_read_b64_tr_b16 v[124:125], v118 offset:64
    ds_read_b64_tr_b16 v[126:127], v118 offset:96
    v_add_f32_dpp v152, v152, v152 quad_perm:[2,3,0,1] row_mask:0xf bank_mask:0xf
    v_add_f32_dpp v153, v153, v153 quad_perm:[2,3,0,1] row_mask:0xf bank_mask:0xf
    ds_read_b64_tr_b16 v[128:129], v118 offset:128
    ds_read_b64_tr_b16 v[130:131], v118 offset:160
    ds_read_b64_tr_b16 v[132:133], v118 offset:192
    ds_read_b64_tr_b16 v[134:135], v118 offset:224
    v_add_f32_dpp v152, v152, v152 row_half_mirror row_mask:0xf bank_mask:0xf
    v_add_f32_dpp v153, v153, v153 row_half_mirror row_mask:0xf bank_mask:0xf
    ds_read_b64_tr_b16 v[136:137], v118 offset:256
    ds_read_b64_tr_b16 v[138:139], v118 offset:288
    ds_read_b64_tr_b16 v[140:141], v118 offset:320
    ds_read_b64_tr_b16 v[142:143], v118 offset:352
    v_mul_f32 v154, 0xbfb8aa3b, v152
    v_exp_f32 v154, v154
    v_mul_f32 v152, v152, v153
    s_lshl_b32 s66, s27, 8
    s_add_u32 s66, s66, 0x15a60
    v_add_f32 v154, 1.0, v154
    v_rcp_f32 v154, v154
    v_lshrrev_b32 v116, 3, v2
    v_lshl_add_u32 v116, v116, 1, s66
    v_mul_f32 v152, v152, v154
    v_cvt_pk_bf16_f32 v152, v152, v152
    ds_write_b16 v116, v152
    v_lshrrev_b32 v116, 4, v2
    v_lshl_add_u32 v116, v116, 3, s66
    v_bfe_u32 v117, v2, 2, 2
    v_lshlrev_b32 v117, 5, v117
    v_sub_u32 v116, v116, v117
    s_waitcnt lgkmcnt(4)
    ds_read_b64_tr_b16 v[144:145], v118 offset:384
    ds_read_b64_tr_b16 v[146:147], v118 offset:416
    ds_read_b64_tr_b16 v[148:149], v118 offset:448
    ds_read_b64_tr_b16 v[150:151], v118 offset:480
    ds_read_b64 v[156:157], v116 offset:0
    ds_read_b64 v[158:159], v116 offset:32
    ds_read_b64 v[160:161], v116 offset:64
    ds_read_b64 v[162:163], v116 offset:96
    v_lshlrev_b32 v117, 2, v2
    s_and_b32 s65, s60, 31
    s_lshl_b32 s65, s65, 11
    s_and_b32 s66, s27, 1
    s_lshl_b32 s66, s66, 10
    s_add_u32 s65, s65, s66
    s_add_u32 s65, s65, 0x860000
    s_waitcnt lgkmcnt(0)
    v_mfma_f32_16x16x16_bf16 v[168:171], v[156:157], v[120:121], 0
    v_mfma_f32_16x16x16_bf16 v[172:175], v[156:157], v[128:129], 0
    v_mfma_f32_16x16x16_bf16 v[176:179], v[156:157], v[136:137], 0
    v_mfma_f32_16x16x16_bf16 v[180:183], v[156:157], v[144:145], 0
    v_mfma_f32_16x16x16_bf16 v[168:171], v[158:159], v[122:123], v[168:171]
    v_mfma_f32_16x16x16_bf16 v[172:175], v[158:159], v[130:131], v[172:175]
    v_mfma_f32_16x16x16_bf16 v[176:179], v[158:159], v[138:139], v[176:179]
    v_mfma_f32_16x16x16_bf16 v[180:183], v[158:159], v[146:147], v[180:183]
    v_mfma_f32_16x16x16_bf16 v[168:171], v[160:161], v[124:125], v[168:171]
    v_mfma_f32_16x16x16_bf16 v[172:175], v[160:161], v[132:133], v[172:175]
    v_mfma_f32_16x16x16_bf16 v[176:179], v[160:161], v[140:141], v[176:179]
    v_mfma_f32_16x16x16_bf16 v[180:183], v[160:161], v[148:149], v[180:183]
    v_mfma_f32_16x16x16_bf16 v[168:171], v[162:163], v[126:127], v[168:171]
    v_mfma_f32_16x16x16_bf16 v[172:175], v[162:163], v[134:135], v[172:175]
    v_mfma_f32_16x16x16_bf16 v[176:179], v[162:163], v[142:143], v[176:179]
    v_mfma_f32_16x16x16_bf16 v[180:183], v[162:163], v[150:151], v[180:183]
    s_nop 7
    buffer_atomic_add_f32 v168, v117, s[32:35], s65 offen offset:0
    buffer_atomic_add_f32 v172, v117, s[32:35], s65 offen offset:256
    buffer_atomic_add_f32 v176, v117, s[32:35], s65 offen offset:512
    buffer_atomic_add_f32 v180, v117, s[32:35], s65 offen offset:768
    s_branch FW_S2_RET
FW_F3:
    s_lshl_b32 s65, s60, 1
    s_and_b32 s66, s27, 1
    s_add_u32 s65, s65, s66
    s_lshl_b32 s65, s65, 2
    s_add_u32 s65, s65, 0x815000
    v_mov_b32 v114, s26
    v_mov_b32 v115, 0
    s_waitcnt vmcnt(0)
    s_mov_b64 exec, 1
    buffer_store_dword v114, v115, s[32:35], s65 offen sc1
    s_mov_b64 exec, -1
    s_branch FW_F3_RET
P2_FALLBACK:
    s_mov_b32 s64, s54
    s_add_u32 s65, s54, 0x20000
    v_mov_b32 v114, 0xff800000
FB_MAX:
    buffer_load_dwordx4 v[196:199], v3, s[32:35], s64 offen sc1
    s_add_u32 s64, s64, 2048
    s_waitcnt vmcnt(0)
    v_mfma_f32_32x32x16_bf16 v[16:31], v[196:199], v[8:11], 0
    s_nop 15
    v_max3_f32 v114, v114, v16, v17
    v_max3_f32 v114, v114, v18, v19
    v_max3_f32 v114, v114, v20, v21
    v_max3_f32 v114, v114, v22, v23
    v_max3_f32 v114, v114, v24, v25
    v_max3_f32 v114, v114, v26, v27
    v_max3_f32 v114, v114, v28, v29
    v_max3_f32 v114, v114, v30, v31
    s_cmp_lt_u32 s64, s65
    s_cbranch_scc1 FB_MAX
    v_mov_b32 v115, v114
    s_nop 1
    v_permlane32_swap_b32 v115, v114
    s_nop 1
    v_max_f32 v114, v114, v115
    v_mul_f32 v80, -1.0, v114
    v_mul_f32 v81, -1.0, v114
    v_mul_f32 v82, -1.0, v114
    v_mul_f32 v83, -1.0, v114
    v_mul_f32 v84, -1.0, v114
    v_mul_f32 v85, -1.0, v114
    v_mul_f32 v86, -1.0, v114
    v_mul_f32 v87, -1.0, v114
    v_mul_f32 v88, -1.0, v114
    v_mul_f32 v89, -1.0, v114
    v_mul_f32 v90, -1.0, v114
    v_mul_f32 v91, -1.0, v114
    v_mul_f32 v92, -1.0, v114
    v_mul_f32 v93, -1.0, v114
    v_mul_f32 v94, -1.0, v114
    v_mul_f32 v95, -1.0, v114
    v_mov_b64 v[64:65], 0
    v_mov_b64 v[66:67], 0
    v_mov_b64 v[68:69], 0
    v_mov_b64 v[70:71], 0
    v_mov_b64 v[72:73], 0
    v_mov_b64 v[74:75], 0
    v_mov_b64 v[76:77], 0
    v_mov_b64 v[78:79], 0
    s_mov_b32 s64, s54
FB_ACC:
    buffer_load_dwordx4 v[196:199], v3, s[32:35], s64 offen sc1
    s_mov_b64 exec, s[58:59]
    buffer_load_dwordx4 v[200:203], v3, s[32:35], s64 offen offset:1024 sc1
    buffer_load_dwordx4 v[204:207], v3, s[32:35], s64 offen offset:1280 sc1
    s_mov_b64 exec, -1
    s_add_u32 s64, s64, 2048
    s_waitcnt vmcnt(0)
    v_mfma_f32_32x32x16_bf16 v[16:31], v[196:199], v[8:11], v[80:95]
    s_nop 15
    v_exp_f32 v16, v16
    v_exp_f32 v17, v17
    v_exp_f32 v18, v18
    v_exp_f32 v19, v19
    v_exp_f32 v20, v20
    v_exp_f32 v21, v21
    v_exp_f32 v22, v22
    v_exp_f32 v23, v23
    v_exp_f32 v24, v24
    v_exp_f32 v25, v25
    v_exp_f32 v26, v26
    v_exp_f32 v27, v27
    v_exp_f32 v28, v28
    v_exp_f32 v29, v29
    v_exp_f32 v30, v30
    v_exp_f32 v31, v31
    s_nop 1
    v_smfmac_f32_32x32x32_bf16 v[64:79], v[200:203], v[16:23], v12
    v_smfmac_f32_32x32x32_bf16 v[64:79], v[204:207], v[24:31], v12
    s_cmp_lt_u32 s64, s65
    s_cbranch_scc1 FB_ACC
    s_nop 15
    v_rcp_f32 v114, v72
    s_nop 0
    v_mul_f32 v64, v64, v114
    v_mul_f32 v65, v65, v114
    v_mul_f32 v66, v66, v114
    v_mul_f32 v67, v67, v114
    v_mul_f32 v68, v68, v114
    v_mul_f32 v69, v69, v114
    v_mul_f32 v70, v70, v114
    v_mul_f32 v71, v71, v114
    s_branch P2_STORE
P3_SLOW:
    v_and_b32 v4, 7, v2
    v_lshlrev_b32 v4, 5, v4
    s_add_u32 s79, s79, 0x10000
    s_mov_b32 s68, 262144
PS_POLL:
    buffer_load_dword v5, v4, s[32:35], s79 offen sc1
    s_sub_u32 s68, s68, 1
    s_cbranch_scc1 PS_OK
    s_waitcnt vmcnt(0)
    v_cmp_ne_u32 vcc, s26, v5
    s_cbranch_vccnz PS_POLL
PS_OK:
    s_lshl_b32 s64, s48, 1
    s_add_u32 s64, s64, s70
    s_lshl_b32 s64, s64, 15
    s_add_u32 s64, s64, 0x600000
    s_add_u32 s65, s64, 0x8000
    v_mov_b32 v9, v11
    v_mov_b64 v[64:65], 0
    v_mov_b64 v[66:67], 0
    v_mov_b64 v[68:69], 0
    v_mov_b64 v[70:71], 0
    v_mov_b64 v[72:73], 0
    v_mov_b64 v[74:75], 0
    v_mov_b64 v[76:77], 0
    v_mov_b64 v[78:79], 0
PS_LOOP:
    s_add_u32 s60, s64, 4096
    buffer_load_dwordx4 v[128:131], v3, s[32:35], s64 offen offset:0 sc1
    buffer_load_dwordx4 v[132:135], v3, s[32:35], s64 offen offset:1024 sc1
    buffer_load_dwordx4 v[136:139], v3, s[32:35], s64 offen offset:2048 sc1
    buffer_load_dwordx4 v[140:143], v3, s[32:35], s64 offen offset:3072 sc1
    buffer_load_dwordx4 v[144:147], v3, s[32:35], s60 offen offset:0 sc1
    buffer_load_dwordx4 v[148:151], v3, s[32:35], s60 offen offset:1024 sc1
    buffer_load_dwordx4 v[152:155], v3, s[32:35], s60 offen offset:2048 sc1
    buffer_load_dwordx4 v[156:159], v3, s[32:35], s60 offen offset:3072 sc1
    ds_read_b64_tr_b16 v[160:161], v9 offset:0
    ds_read_b64_tr_b16 v[162:163], v9 offset:1024
    ds_read_b64_tr_b16 v[164:165], v9 offset:2048
    ds_read_b64_tr_b16 v[166:167], v9 offset:3072
    ds_read_b64_tr_b16 v[168:169], v9 offset:4096
    ds_read_b64_tr_b16 v[170:171], v9 offset:5120
    ds_read_b64_tr_b16 v[172:173], v9 offset:6144
    ds_read_b64_tr_b16 v[174:175], v9 offset:7168
    ds_read_b64_tr_b16 v[176:177], v9 offset:8192
    ds_read_b64_tr_b16 v[178:179], v9 offset:9216
    ds_read_b64_tr_b16 v[180:181], v9 offset:10240
    ds_read_b64_tr_b16 v[182:183], v9 offset:11264
    ds_read_b64_tr_b16 v[184:185], v9 offset:12288
    ds_read_b64_tr_b16 v[186:187], v9 offset:13312
    ds_read_b64_tr_b16 v[188:189], v9 offset:14336
    ds_read_b64_tr_b16 v[190:191], v9 offset:15360
    v_add_u32 v9, 0x4000, v9
    s_add_u32 s64, s64, 0x2000
    s_waitcnt vmcnt(0) lgkmcnt(0)
    v_mfma_f32_32x32x16_bf16 v[64:79], v[160:163], v[128:131], v[64:79]
    v_mfma_f32_32x32x16_bf16 v[64:79], v[164:167], v[132:135], v[64:79]
    v_mfma_f32_32x32x16_bf16 v[64:79], v[168:171], v[136:139], v[64:79]
    v_mfma_f32_32x32x16_bf16 v[64:79], v[172:175], v[140:143], v[64:79]
    v_mfma_f32_32x32x16_bf16 v[64:79], v[176:179], v[144:147], v[64:79]
    v_mfma_f32_32x32x16_bf16 v[64:79], v[180:183], v[148:151], v[64:79]
    v_mfma_f32_32x32x16_bf16 v[64:79], v[184:187], v[152:155], v[64:79]
    v_mfma_f32_32x32x16_bf16 v[64:79], v[188:191], v[156:159], v[64:79]
    s_cmp_lt_u32 s64, s65
    s_cbranch_scc1 PS_LOOP
    s_nop 12
    s_branch P3_FIN
L_CODE_END:
.section .rodata,"a"
.p2align 6
.amdhsa_kernel gated_mix__mha_block__moe_arch_mod__prompt_kernel
  .amdhsa_next_free_vgpr 256
  .amdhsa_next_free_sgpr 100
  .amdhsa_accum_offset 256
  .amdhsa_group_segment_fixed_size 0
  .amdhsa_kernarg_size 96
  .amdhsa_user_sgpr_count 2
  .amdhsa_user_sgpr_kernarg_segment_ptr 1
  .amdhsa_system_sgpr_workgroup_id_x 1
.end_amdhsa_kernel
```
